```python
import torch

def _softmax(x, axis=-1):
    return torch.softmax(x, dim=axis)
def _gelu(x):
    return torch.nn.functional.gelu(x, approximate="tanh")
def _silu(x):
    return torch.nn.functional.silu(x)
def _sigmoid(x):
    return torch.sigmoid(x)
def _layernorm(x, axis=-1, eps=1e-5):
    m = x.mean(dim=axis, keepdim=True)
    v = x.var(dim=axis, keepdim=True, unbiased=False)
    return (x - m) / torch.sqrt(v + eps)
def _scatter_add(tgt, idx, src, axis=0):
    return tgt.clone().index_add_(axis, idx, src)
def _segment_sum(src, seg, n):
    out = torch.zeros((n,) + src.shape[1:], dtype=src.dtype)
    return out.index_add_(0, seg, src)
def _pad(x, pw):
    flat = tuple(v for pair in reversed(pw) for v in pair)
    return torch.nn.functional.pad(x, flat)

kernel_name = 'gated_mix__mha_block__grouped_kv_mqa__prompt'

def setup_inputs():

    _w = (lambda a: (lambda t: t.to(torch.bfloat16) if t.is_floating_point() else t)(torch.as_tensor(a)))
    def _A_setup():
        B, S, D, H = 1, 2048, 640, 32
        return {
            "x": _w((lambda *s: torch.randn(*s, dtype=torch.bfloat16) * 0.1)(B, S, D)),
            "wqkv": _w((lambda *s: torch.randn(*s, dtype=torch.bfloat16) * 0.4)(D, 3 * D)),
            "wo": _w((lambda *s: torch.randn(*s, dtype=torch.bfloat16) * 0.2)(D, D)),
        }
    _A_in = _A_setup()

    def _B_setup():
        B, S, D, H = 1, 2048, 640, 32
        Dh = D // H
        return {
            "x": _w((lambda *s: torch.randn(*s, dtype=torch.bfloat16) * 0.1)(B, S, D)),
            "wq": _w((lambda *s: torch.randn(*s, dtype=torch.bfloat16) * 0.4)(D, H * Dh)),
            "wk": _w((lambda *s: torch.randn(*s, dtype=torch.bfloat16) * 0.4)(D, Dh)),
            "wv": _w((lambda *s: torch.randn(*s, dtype=torch.bfloat16) * 0.4)(D, Dh)),
            "wo": _w((lambda *s: torch.randn(*s, dtype=torch.bfloat16) * 0.4)(H * Dh, D)),
        }
    _B_in = _B_setup()

    return {
        "A_x": _A_in["x"],
        "A_wqkv": _A_in["wqkv"],
        "A_wo": _A_in["wo"],
        "B_x": _B_in["x"],
        "B_wq": _B_in["wq"],
        "B_wk": _B_in["wk"],
        "B_wv": _B_in["wv"],
        "B_wo": _B_in["wo"],
        "gate_w": _w((lambda *s: torch.randn(*s, dtype=torch.bfloat16) * 0.1)(640) * 16.0),
    }

def reference(A_x, A_wqkv, A_wo, B_x, B_wq, B_wk, B_wv, B_wo, gate_w):
    def _A_ref(x, wqkv, wo):
        B, S, D = x.shape
        H = 32
        Dh = D // H
        qkv = (lambda x, *d: x.permute(*d))((x @ wqkv).reshape(B, S, 3, H, Dh), 2, 0, 3, 1, 4)
        q, k, v = qkv[0], qkv[1], qkv[2]
        scores = torch.einsum("bhqd,bhkd->bhqk", q, k) * (Dh ** -0.5)
        p = _softmax(scores, axis=-1)
        o = torch.einsum("bhqk,bhkd->bhqd", p, v)
        return (lambda x, *d: x.permute(*d))(o, 0, 2, 1, 3).reshape(B, S, D) @ wo

    def _B_ref(x, wq, wk, wv, wo):
        B, S, D = x.shape
        H = 32
        Dh = D // H
        q = (lambda x, *d: x.permute(*d))((x @ wq).reshape(B, S, H, Dh), 0, 2, 1, 3)
        k = x @ wk
        v = x @ wv
        scores = torch.einsum("bhqd,bkd->bhqk", q, k) * (Dh ** -0.5)
        p = _softmax(scores, axis=-1)
        o = torch.einsum("bhqk,bkd->bhqd", p, v)
        return (lambda x, *d: x.permute(*d))(o, 0, 2, 1, 3).reshape(B, S, H * Dh) @ wo

    x = A_x
    g = _sigmoid((x * gate_w).sum(-1, keepdims=True))
    a = _A_ref(x, A_wqkv, A_wo)
    b = _B_ref(x, B_wq, B_wk, B_wv, B_wo)
    return g * a + (1 - g) * b
```

```asm
; @launch kernel=gmix_proj_kernel grid=(256,1,1) block=(512,1,1) lds=157696
; @launch kernel=gmix_attn_kernel grid=(256,1,1) block=(512,1,1) lds=163840
.amdgcn_target "amdgcn-amd-amdhsa--gfx950"
.text
.globl gmix_proj_kernel
.p2align 8
.type gmix_proj_kernel,@function
gmix_proj_kernel:
    s_cmp_ge_u32 s2, 256
    s_cbranch_scc1 L_k1_exit
    s_load_dwordx4 s[4:7], s[0:1], 0
    s_load_dwordx4 s[8:11], s[0:1], 32
    s_load_dwordx2 s[12:13], s[0:1], 48
    s_load_dwordx2 s[14:15], s[0:1], 64
    s_load_dwordx2 s[16:17], s[0:1], 88
    v_lshrrev_b32 v2, 6, v0
    v_and_b32 v1, 63, v0
    s_and_b32 s56, s2, 7
    s_lshr_b32 s57, s2, 3
    v_readfirstlane_b32 s42, v2
    s_and_b32 s40, s56, 1
    s_lshl_b32 s40, s40, 3
    s_and_b32 s58, s57, 7
    s_add_u32 s40, s40, s58
    s_lshr_b32 s41, s56, 1
    s_lshl_b32 s41, s41, 2
    s_lshr_b32 s45, s57, 3
    s_add_u32 s41, s41, s45
    s_and_b32 s78, s42, 3
    s_lshr_b32 s43, s78, 1
    s_and_b32 s44, s78, 1
    s_mov_b32 s74, 0x00010001
    s_mov_b32 s75, 0x00010001
    s_lshl_b32 s57, s43, 2
    s_add_u32 s56, s45, 0
    s_and_b32 s56, s56, 3
    s_add_u32 s66, s56, s57
    s_add_u32 s56, s45, 1
    s_and_b32 s56, s56, 3
    s_add_u32 s67, s56, s57
    s_add_u32 s56, s45, 2
    s_and_b32 s56, s56, 3
    s_add_u32 s68, s56, s57
    s_add_u32 s56, s45, 3
    s_and_b32 s56, s56, 3
    s_add_u32 s69, s56, s57
    s_cmp_lt_u32 s42, 4
    s_cbranch_scc1 L_k1_compute
    s_mov_b32 s54, -1
    s_mov_b32 s55, 0xff
    s_lshl_b32 s50, s78, 12
    s_mul_i32 s51, s78, 5120
    s_mul_i32 s52, s78, 640
    s_mov_b32 s76, 0
    s_mov_b32 s77, 0
    s_cmp_lt_u32 s41, 12
    s_mov_b32 s46, 1280
    s_cmov_b32 s46, 3840
    s_cselect_b32 s56, 0, 12
    s_sub_u32 s56, s41, s56
    s_mul_i32 s59, s56, 320
    s_lshl_b32 s70, s46, 6
    s_bfe_u32 s71, s41, 0x10002
    v_lshrrev_b32 v2, 3, v1
    v_and_b32 v3, 7, v1
    v_xor_b32 v3, v3, v2
    v_lshlrev_b32 v3, 4, v3
    v_mul_u32_u24 v2, 1280, v2
    v_add_u32 v2, v2, v3
    s_lshl_b32 s57, s40, 7
    s_cmp_eq_u32 s44, 0
    s_cselect_b32 s56, s66, s68
    s_lshl_b32 s56, s56, 4
    s_add_u32 s56, s56, s57
    s_mul_i32 s56, s56, 1280
    v_add_u32 v16, s56, v2
    v_add_u32 v17, 10240, v16
    s_cmp_eq_u32 s44, 0
    s_cselect_b32 s56, s67, s69
    s_lshl_b32 s56, s56, 4
    s_add_u32 s56, s56, s57
    s_mul_i32 s56, s56, 1280
    v_add_u32 v18, s56, v2
    v_add_u32 v19, 10240, v18
    s_mul_i32 s56, s43, 160
    s_add_u32 s56, s56, s59
    s_lshl_b32 s57, s44, 5
    s_mul_i32 s57, s57, s46
    s_add_u32 s56, s56, s57
    v_add_u32 v2, 0, v1
    v_mul_u32_u24 v3, 205, v2
    v_lshrrev_b32 v3, 11, v3
    v_mul_u32_u24 v4, 10, v3
    v_sub_u32 v4, v2, v4
    v_lshrrev_b32 v5, 4, v3
    v_and_b32 v6, 3, v3
    v_lshl_add_u32 v5, v5, 2, v6
    v_bfe_u32 v6, v3, 2, 2
    v_lshl_add_u32 v5, v6, 3, v5
    v_mul_lo_u32 v5, v5, s46
    v_lshlrev_b32 v4, 4, v4
    v_add3_u32 v20, v5, v4, s56
    v_add_u32 v2, 64, v1
    v_mul_u32_u24 v3, 205, v2
    v_lshrrev_b32 v3, 11, v3
    v_mul_u32_u24 v4, 10, v3
    v_sub_u32 v4, v2, v4
    v_lshrrev_b32 v5, 4, v3
    v_and_b32 v6, 3, v3
    v_lshl_add_u32 v5, v5, 2, v6
    v_bfe_u32 v6, v3, 2, 2
    v_lshl_add_u32 v5, v6, 3, v5
    v_mul_lo_u32 v5, v5, s46
    v_lshlrev_b32 v4, 4, v4
    v_add3_u32 v21, v5, v4, s56
    v_add_u32 v2, 128, v1
    v_mul_u32_u24 v3, 205, v2
    v_lshrrev_b32 v3, 11, v3
    v_mul_u32_u24 v4, 10, v3
    v_sub_u32 v4, v2, v4
    v_lshrrev_b32 v5, 4, v3
    v_and_b32 v6, 3, v3
    v_lshl_add_u32 v5, v5, 2, v6
    v_bfe_u32 v6, v3, 2, 2
    v_lshl_add_u32 v5, v6, 3, v5
    v_mul_lo_u32 v5, v5, s46
    v_lshlrev_b32 v4, 4, v4
    v_add3_u32 v22, v5, v4, s56
    v_add_u32 v2, 192, v1
    v_mul_u32_u24 v3, 205, v2
    v_lshrrev_b32 v3, 11, v3
    v_mul_u32_u24 v4, 10, v3
    v_sub_u32 v4, v2, v4
    v_lshrrev_b32 v5, 4, v3
    v_and_b32 v6, 3, v3
    v_lshl_add_u32 v5, v5, 2, v6
    v_bfe_u32 v6, v3, 2, 2
    v_lshl_add_u32 v5, v6, 3, v5
    v_mul_lo_u32 v5, v5, s46
    v_lshlrev_b32 v4, 4, v4
    v_add3_u32 v23, v5, v4, s56
    v_add_u32 v2, 256, v1
    v_mul_u32_u24 v3, 205, v2
    v_lshrrev_b32 v3, 11, v3
    v_mul_u32_u24 v4, 10, v3
    v_sub_u32 v4, v2, v4
    v_lshrrev_b32 v5, 4, v3
    v_and_b32 v6, 3, v3
    v_lshl_add_u32 v5, v5, 2, v6
    v_bfe_u32 v6, v3, 2, 2
    v_lshl_add_u32 v5, v6, 3, v5
    v_mul_lo_u32 v5, v5, s46
    v_lshlrev_b32 v4, 4, v4
    v_add3_u32 v24, v5, v4, s56
    v_lshlrev_b32 v25, 4, v1
    v_add_u32 v25, s52, v25
    s_and_b32 s56, s40, 7
    s_add_u32 s56, s56, s45
    s_mul_i32 s57, s56, 52
    s_lshr_b32 s57, s57, 8
    s_mul_i32 s57, s57, 5
    s_sub_u32 s56, s56, s57
    s_lshl_b32 s56, s56, 1
    s_lshl_b32 s47, s56, 7
    s_mul_i32 s48, s56, s70
    s_mul_i32 s49, s56, 2560
    s_waitcnt lgkmcnt(0)
    s_mov_b32 s20, s4
    s_and_b32 s21, s5, 0xffff
    s_mov_b32 s22, 2621440
    s_mov_b32 s23, 0x00020000
    s_cmp_lt_u32 s41, 12
    s_cselect_b32 s24, s6, s8
    s_cselect_b32 s25, s7, s9
    s_mov_b32 s26, 819200
    s_cmov_b32 s26, 2457600
    s_and_b32 s25, s25, 0xffff
    s_mov_b32 s27, 0x00020000
    s_lshr_b32 s56, s41, 2
    s_cmp_eq_u32 s56, 2
    s_cselect_b32 s28, s12, s10
    s_cselect_b32 s29, s13, s11
    s_and_b32 s29, s29, 0xffff
    s_mov_b32 s30, 25600
    s_mov_b32 s31, 0x00020000
L_k1_ld:
    s_cmp_lt_u32 s77, 2
    s_cbranch_scc1 L_k1_ld2
    s_waitcnt vmcnt(10)
    s_barrier
L_k1_ld2:
    s_add_u32 s56, s50, s76
    s_add_u32 s57, s51, s76
    s_add_u32 s58, s52, s76
    s_add_u32 m0, s56, 0
    s_nop 0
    buffer_load_dwordx4 v16, s[20:23], s47 offen lds
    s_add_u32 m0, s56, 1024
    s_nop 0
    buffer_load_dwordx4 v17, s[20:23], s47 offen lds
    s_add_u32 m0, s56, 2048
    s_nop 0
    buffer_load_dwordx4 v18, s[20:23], s47 offen lds
    s_add_u32 m0, s56, 3072
    s_nop 0
    buffer_load_dwordx4 v19, s[20:23], s47 offen lds
    s_add_u32 m0, s57, 16384
    s_nop 0
    buffer_load_dwordx4 v20, s[24:27], s48 offen lds
    s_add_u32 m0, s57, 17408
    s_nop 0
    buffer_load_dwordx4 v21, s[24:27], s48 offen lds
    s_add_u32 m0, s57, 18432
    s_nop 0
    buffer_load_dwordx4 v22, s[24:27], s48 offen lds
    s_add_u32 m0, s57, 19456
    s_nop 0
    buffer_load_dwordx4 v23, s[24:27], s48 offen lds
    s_add_u32 m0, s57, 20480
    s_nop 0
    buffer_load_dwordx4 v24, s[24:27], s48 offen lds
    s_add_u32 m0, s58, 36864
    s_mov_b64 exec, s[54:55]
    buffer_load_dwordx4 v25, s[28:31], s49 offen lds
    s_mov_b64 exec, -1
    s_add_u32 s47, s47, 128
    s_add_u32 s48, s48, s70
    s_add_u32 s49, s49, 2560
    s_cmp_eq_u32 s47, 1280
    s_cmov_b32 s47, 0
    s_cmov_b32 s48, 0
    s_cmov_b32 s49, 0
    s_add_u32 s76, s76, 39424
    s_cmp_eq_u32 s76, 157696
    s_cmov_b32 s76, 0
    s_add_u32 s77, s77, 1
    s_cmp_lt_u32 s77, 10
    s_cbranch_scc1 L_k1_ld
    s_waitcnt vmcnt(10)
    s_barrier
    s_waitcnt vmcnt(0)
    s_barrier
    s_mov_b32 s32, s16
    s_and_b32 s33, s17, 0xffff
    s_mov_b32 s34, 18874368
    s_mov_b32 s35, 0x00020000
    s_mov_b32 s36, s14
    s_and_b32 s37, s15, 0xffff
    s_mov_b32 s38, 1280
    s_mov_b32 s39, 0x00020000
    s_cmp_lg_u32 s71, 0
    s_cbranch_scc1 L_k1_gate
    s_barrier
    s_branch L_k1_done
L_k1_gate:
    s_lshr_b32 s56, s41, 3
    s_lshl_b32 s56, s56, 2
    s_add_u32 s56, s56, s45
    s_lshl_b32 s56, s56, 4
    s_lshl_b32 s57, s40, 7
    s_add_u32 s56, s56, s57
    s_lshl_b32 s57, s78, 2
    s_add_u32 s56, s56, s57
    v_lshrrev_b32 v2, 4, v1
    v_add_u32 v37, s56, v2
    v_and_b32 v3, 15, v1
    v_lshlrev_b32 v3, 4, v3
    v_mul_u32_u24 v2, 1280, v37
    v_add_u32 v2, v2, v3
    buffer_load_dwordx4 v[212:215], v2, s[20:23], 0 offen offset:0
    buffer_load_dwordx4 v[232:235], v3, s[36:39], 0 offen offset:0
    buffer_load_dwordx4 v[216:219], v2, s[20:23], 0 offen offset:256
    buffer_load_dwordx4 v[236:239], v3, s[36:39], 0 offen offset:256
    buffer_load_dwordx4 v[220:223], v2, s[20:23], 0 offen offset:512
    buffer_load_dwordx4 v[240:243], v3, s[36:39], 0 offen offset:512
    buffer_load_dwordx4 v[224:227], v2, s[20:23], 0 offen offset:768
    buffer_load_dwordx4 v[244:247], v3, s[36:39], 0 offen offset:768
    buffer_load_dwordx4 v[228:231], v2, s[20:23], 0 offen offset:1024
    buffer_load_dwordx4 v[248:251], v3, s[36:39], 0 offen offset:1024
    s_barrier
    v_mov_b32 v2, 0
    v_mov_b32 v3, 0
    s_waitcnt vmcnt(0)
    v_lshlrev_b32 v4, 16, v212
    v_lshlrev_b32 v5, 16, v232
    v_and_b32 v6, 0xffff0000, v212
    v_and_b32 v7, 0xffff0000, v232
    v_mul_f32 v4, v4, v5
    v_mul_f32 v6, v6, v7
    v_cvt_pk_bf16_f32 v4, v4, v6
    v_lshlrev_b32 v5, 16, v4
    v_and_b32 v6, 0xffff0000, v4
    v_add_f32 v2, v2, v5
    v_add_f32 v3, v3, v6
    v_lshlrev_b32 v4, 16, v213
    v_lshlrev_b32 v5, 16, v233
    v_and_b32 v6, 0xffff0000, v213
    v_and_b32 v7, 0xffff0000, v233
    v_mul_f32 v4, v4, v5
    v_mul_f32 v6, v6, v7
    v_cvt_pk_bf16_f32 v4, v4, v6
    v_lshlrev_b32 v5, 16, v4
    v_and_b32 v6, 0xffff0000, v4
    v_add_f32 v2, v2, v5
    v_add_f32 v3, v3, v6
    v_lshlrev_b32 v4, 16, v214
    v_lshlrev_b32 v5, 16, v234
    v_and_b32 v6, 0xffff0000, v214
    v_and_b32 v7, 0xffff0000, v234
    v_mul_f32 v4, v4, v5
    v_mul_f32 v6, v6, v7
    v_cvt_pk_bf16_f32 v4, v4, v6
    v_lshlrev_b32 v5, 16, v4
    v_and_b32 v6, 0xffff0000, v4
    v_add_f32 v2, v2, v5
    v_add_f32 v3, v3, v6
    v_lshlrev_b32 v4, 16, v215
    v_lshlrev_b32 v5, 16, v235
    v_and_b32 v6, 0xffff0000, v215
    v_and_b32 v7, 0xffff0000, v235
    v_mul_f32 v4, v4, v5
    v_mul_f32 v6, v6, v7
    v_cvt_pk_bf16_f32 v4, v4, v6
    v_lshlrev_b32 v5, 16, v4
    v_and_b32 v6, 0xffff0000, v4
    v_add_f32 v2, v2, v5
    v_add_f32 v3, v3, v6
    v_lshlrev_b32 v4, 16, v216
    v_lshlrev_b32 v5, 16, v236
    v_and_b32 v6, 0xffff0000, v216
    v_and_b32 v7, 0xffff0000, v236
    v_mul_f32 v4, v4, v5
    v_mul_f32 v6, v6, v7
    v_cvt_pk_bf16_f32 v4, v4, v6
    v_lshlrev_b32 v5, 16, v4
    v_and_b32 v6, 0xffff0000, v4
    v_add_f32 v2, v2, v5
    v_add_f32 v3, v3, v6
    v_lshlrev_b32 v4, 16, v217
    v_lshlrev_b32 v5, 16, v237
    v_and_b32 v6, 0xffff0000, v217
    v_and_b32 v7, 0xffff0000, v237
    v_mul_f32 v4, v4, v5
    v_mul_f32 v6, v6, v7
    v_cvt_pk_bf16_f32 v4, v4, v6
    v_lshlrev_b32 v5, 16, v4
    v_and_b32 v6, 0xffff0000, v4
    v_add_f32 v2, v2, v5
    v_add_f32 v3, v3, v6
    v_lshlrev_b32 v4, 16, v218
    v_lshlrev_b32 v5, 16, v238
    v_and_b32 v6, 0xffff0000, v218
    v_and_b32 v7, 0xffff0000, v238
    v_mul_f32 v4, v4, v5
    v_mul_f32 v6, v6, v7
    v_cvt_pk_bf16_f32 v4, v4, v6
    v_lshlrev_b32 v5, 16, v4
    v_and_b32 v6, 0xffff0000, v4
    v_add_f32 v2, v2, v5
    v_add_f32 v3, v3, v6
    v_lshlrev_b32 v4, 16, v219
    v_lshlrev_b32 v5, 16, v239
    v_and_b32 v6, 0xffff0000, v219
    v_and_b32 v7, 0xffff0000, v239
    v_mul_f32 v4, v4, v5
    v_mul_f32 v6, v6, v7
    v_cvt_pk_bf16_f32 v4, v4, v6
    v_lshlrev_b32 v5, 16, v4
    v_and_b32 v6, 0xffff0000, v4
    v_add_f32 v2, v2, v5
    v_add_f32 v3, v3, v6
    v_lshlrev_b32 v4, 16, v220
    v_lshlrev_b32 v5, 16, v240
    v_and_b32 v6, 0xffff0000, v220
    v_and_b32 v7, 0xffff0000, v240
    v_mul_f32 v4, v4, v5
    v_mul_f32 v6, v6, v7
    v_cvt_pk_bf16_f32 v4, v4, v6
    v_lshlrev_b32 v5, 16, v4
    v_and_b32 v6, 0xffff0000, v4
    v_add_f32 v2, v2, v5
    v_add_f32 v3, v3, v6
    v_lshlrev_b32 v4, 16, v221
    v_lshlrev_b32 v5, 16, v241
    v_and_b32 v6, 0xffff0000, v221
    v_and_b32 v7, 0xffff0000, v241
    v_mul_f32 v4, v4, v5
    v_mul_f32 v6, v6, v7
    v_cvt_pk_bf16_f32 v4, v4, v6
    v_lshlrev_b32 v5, 16, v4
    v_and_b32 v6, 0xffff0000, v4
    v_add_f32 v2, v2, v5
    v_add_f32 v3, v3, v6
    v_lshlrev_b32 v4, 16, v222
    v_lshlrev_b32 v5, 16, v242
    v_and_b32 v6, 0xffff0000, v222
    v_and_b32 v7, 0xffff0000, v242
    v_mul_f32 v4, v4, v5
    v_mul_f32 v6, v6, v7
    v_cvt_pk_bf16_f32 v4, v4, v6
    v_lshlrev_b32 v5, 16, v4
    v_and_b32 v6, 0xffff0000, v4
    v_add_f32 v2, v2, v5
    v_add_f32 v3, v3, v6
    v_lshlrev_b32 v4, 16, v223
    v_lshlrev_b32 v5, 16, v243
    v_and_b32 v6, 0xffff0000, v223
    v_and_b32 v7, 0xffff0000, v243
    v_mul_f32 v4, v4, v5
    v_mul_f32 v6, v6, v7
    v_cvt_pk_bf16_f32 v4, v4, v6
    v_lshlrev_b32 v5, 16, v4
    v_and_b32 v6, 0xffff0000, v4
    v_add_f32 v2, v2, v5
    v_add_f32 v3, v3, v6
    v_lshlrev_b32 v4, 16, v224
    v_lshlrev_b32 v5, 16, v244
    v_and_b32 v6, 0xffff0000, v224
    v_and_b32 v7, 0xffff0000, v244
    v_mul_f32 v4, v4, v5
    v_mul_f32 v6, v6, v7
    v_cvt_pk_bf16_f32 v4, v4, v6
    v_lshlrev_b32 v5, 16, v4
    v_and_b32 v6, 0xffff0000, v4
    v_add_f32 v2, v2, v5
    v_add_f32 v3, v3, v6
    v_lshlrev_b32 v4, 16, v225
    v_lshlrev_b32 v5, 16, v245
    v_and_b32 v6, 0xffff0000, v225
    v_and_b32 v7, 0xffff0000, v245
    v_mul_f32 v4, v4, v5
    v_mul_f32 v6, v6, v7
    v_cvt_pk_bf16_f32 v4, v4, v6
    v_lshlrev_b32 v5, 16, v4
    v_and_b32 v6, 0xffff0000, v4
    v_add_f32 v2, v2, v5
    v_add_f32 v3, v3, v6
    v_lshlrev_b32 v4, 16, v226
    v_lshlrev_b32 v5, 16, v246
    v_and_b32 v6, 0xffff0000, v226
    v_and_b32 v7, 0xffff0000, v246
    v_mul_f32 v4, v4, v5
    v_mul_f32 v6, v6, v7
    v_cvt_pk_bf16_f32 v4, v4, v6
    v_lshlrev_b32 v5, 16, v4
    v_and_b32 v6, 0xffff0000, v4
    v_add_f32 v2, v2, v5
    v_add_f32 v3, v3, v6
    v_lshlrev_b32 v4, 16, v227
    v_lshlrev_b32 v5, 16, v247
    v_and_b32 v6, 0xffff0000, v227
    v_and_b32 v7, 0xffff0000, v247
    v_mul_f32 v4, v4, v5
    v_mul_f32 v6, v6, v7
    v_cvt_pk_bf16_f32 v4, v4, v6
    v_lshlrev_b32 v5, 16, v4
    v_and_b32 v6, 0xffff0000, v4
    v_add_f32 v2, v2, v5
    v_add_f32 v3, v3, v6
    v_lshlrev_b32 v4, 16, v228
    v_lshlrev_b32 v5, 16, v248
    v_and_b32 v6, 0xffff0000, v228
    v_and_b32 v7, 0xffff0000, v248
    v_mul_f32 v4, v4, v5
    v_mul_f32 v6, v6, v7
    v_cvt_pk_bf16_f32 v4, v4, v6
    v_lshlrev_b32 v5, 16, v4
    v_and_b32 v6, 0xffff0000, v4
    v_add_f32 v2, v2, v5
    v_add_f32 v3, v3, v6
    v_lshlrev_b32 v4, 16, v229
    v_lshlrev_b32 v5, 16, v249
    v_and_b32 v6, 0xffff0000, v229
    v_and_b32 v7, 0xffff0000, v249
    v_mul_f32 v4, v4, v5
    v_mul_f32 v6, v6, v7
    v_cvt_pk_bf16_f32 v4, v4, v6
    v_lshlrev_b32 v5, 16, v4
    v_and_b32 v6, 0xffff0000, v4
    v_add_f32 v2, v2, v5
    v_add_f32 v3, v3, v6
    v_lshlrev_b32 v4, 16, v230
    v_lshlrev_b32 v5, 16, v250
    v_and_b32 v6, 0xffff0000, v230
    v_and_b32 v7, 0xffff0000, v250
    v_mul_f32 v4, v4, v5
    v_mul_f32 v6, v6, v7
    v_cvt_pk_bf16_f32 v4, v4, v6
    v_lshlrev_b32 v5, 16, v4
    v_and_b32 v6, 0xffff0000, v4
    v_add_f32 v2, v2, v5
    v_add_f32 v3, v3, v6
    v_lshlrev_b32 v4, 16, v231
    v_lshlrev_b32 v5, 16, v251
    v_and_b32 v6, 0xffff0000, v231
    v_and_b32 v7, 0xffff0000, v251
    v_mul_f32 v4, v4, v5
    v_mul_f32 v6, v6, v7
    v_cvt_pk_bf16_f32 v4, v4, v6
    v_lshlrev_b32 v5, 16, v4
    v_and_b32 v6, 0xffff0000, v4
    v_add_f32 v2, v2, v5
    v_add_f32 v3, v3, v6
    v_add_f32 v2, v2, v3
    s_nop 1
    v_add_f32_dpp v2, v2, v2 row_ror:8 row_mask:0xf bank_mask:0xf
    s_nop 1
    v_add_f32_dpp v2, v2, v2 row_ror:4 row_mask:0xf bank_mask:0xf
    s_nop 1
    v_add_f32_dpp v2, v2, v2 row_ror:2 row_mask:0xf bank_mask:0xf
    s_nop 1
    v_add_f32_dpp v2, v2, v2 row_ror:1 row_mask:0xf bank_mask:0xf
    v_cvt_pk_bf16_f32 v2, v2, v2
    v_lshlrev_b32 v2, 16, v2
    v_mul_f32 v2, 0xbfb8aa3b, v2
    v_exp_f32 v2, v2
    s_nop 0
    v_add_f32 v2, 1.0, v2
    v_rcp_f32 v2, v2
    s_nop 0
    v_cvt_pk_bf16_f32 v2, v2, v2
    v_lshlrev_b32 v36, 16, v2
    v_sub_f32 v2, 1.0, v36
    v_cvt_pk_bf16_f32 v2, v2, v2
    v_lshlrev_b32 v2, 16, v2
    v_lshlrev_b32 v3, 2, v37
    s_mov_b32 s56, 11599872
    s_mov_b32 s57, 11608064
    s_mov_b64 exec, s[74:75]
    buffer_store_dword v36, v3, s[32:35], s56 offen sc1
    buffer_store_dword v2, v3, s[32:35], s57 offen sc1
    s_branch L_k1_done
L_k1_compute:
    s_getpc_b64 s[20:21]
L_k1_pc:
    s_sub_u32 s20, s20, L_k1_pc-gmix_proj_kernel
    s_subb_u32 s21, s21, 0
    s_and_b32 s21, s21, 0xffff
    s_mov_b32 s22, L_code_end-gmix_proj_kernel
    s_mov_b32 s23, 0x00020000
    v_lshlrev_b32 v4, 7, v0
    buffer_load_dword v212, v4, s[20:23], 0 offen
    s_mov_b32 s72, 0xffff
    s_mov_b32 s73, 0
    v_and_b32 v2, 15, v1
    v_lshrrev_b32 v3, 4, v1
    v_and_b32 v4, 7, v1
    v_xor_b32 v4, v4, v3
    v_lshlrev_b32 v4, 4, v4
    v_lshlrev_b32 v5, 7, v2
    s_lshl_b32 s56, s43, 13
    v_add3_u32 v26, v5, v4, s56
    v_xor_b32 v27, 64, v26
    v_lshrrev_b32 v4, 2, v2
    v_and_b32 v5, 3, v1
    v_lshl_add_u32 v6, v3, 2, v4
    v_mul_u32_u24 v6, 160, v6
    s_mul_i32 s56, s44, 10240
    s_add_u32 s56, s56, 16384
    v_add_u32 v6, s56, v6
    v_lshlrev_b32 v7, 3, v5
    v_add_u32 v28, v6, v7
    v_mul_u32_u24 v8, 40, v5
    v_add3_u32 v29, v6, v8, 32
    v_lshl_add_u32 v6, v3, 3, v4
    v_mul_u32_u24 v6, 40, v6
    v_mov_b32 v8, 32
    s_cmp_eq_u32 s44, 0
    s_cselect_b64 vcc, -1, 0
    v_add_u32 v6, 36864, v6
    v_cndmask_b32 v7, v8, v7, vcc
    v_add_u32 v30, v6, v7
    v_mov_b32 v128, 0
    v_mov_b32 v129, 0
    v_mov_b32 v130, 0
    v_mov_b32 v131, 0
    v_mov_b32 v132, 0
    v_mov_b32 v133, 0
    v_mov_b32 v134, 0
    v_mov_b32 v135, 0
    v_mov_b32 v136, 0
    v_mov_b32 v137, 0
    v_mov_b32 v138, 0
    v_mov_b32 v139, 0
    v_mov_b32 v140, 0
    v_mov_b32 v141, 0
    v_mov_b32 v142, 0
    v_mov_b32 v143, 0
    v_mov_b32 v144, 0
    v_mov_b32 v145, 0
    v_mov_b32 v146, 0
    v_mov_b32 v147, 0
    v_mov_b32 v148, 0
    v_mov_b32 v149, 0
    v_mov_b32 v150, 0
    v_mov_b32 v151, 0
    v_mov_b32 v152, 0
    v_mov_b32 v153, 0
    v_mov_b32 v154, 0
    v_mov_b32 v155, 0
    v_mov_b32 v156, 0
    v_mov_b32 v157, 0
    v_mov_b32 v158, 0
    v_mov_b32 v159, 0
    v_mov_b32 v160, 0
    v_mov_b32 v161, 0
    v_mov_b32 v162, 0
    v_mov_b32 v163, 0
    v_mov_b32 v164, 0
    v_mov_b32 v165, 0
    v_mov_b32 v166, 0
    v_mov_b32 v167, 0
    v_mov_b32 v168, 0
    v_mov_b32 v169, 0
    v_mov_b32 v170, 0
    v_mov_b32 v171, 0
    v_mov_b32 v172, 0
    v_mov_b32 v173, 0
    v_mov_b32 v174, 0
    v_mov_b32 v175, 0
    v_mov_b32 v176, 0
    v_mov_b32 v177, 0
    v_mov_b32 v178, 0
    v_mov_b32 v179, 0
    v_mov_b32 v180, 0
    v_mov_b32 v181, 0
    v_mov_b32 v182, 0
    v_mov_b32 v183, 0
    v_mov_b32 v184, 0
    v_mov_b32 v185, 0
    v_mov_b32 v186, 0
    v_mov_b32 v187, 0
    v_mov_b32 v188, 0
    v_mov_b32 v189, 0
    v_mov_b32 v190, 0
    v_mov_b32 v191, 0
    v_mov_b32 v192, 0
    v_mov_b32 v193, 0
    v_mov_b32 v194, 0
    v_mov_b32 v195, 0
    v_mov_b32 v196, 0
    v_mov_b32 v197, 0
    v_mov_b32 v198, 0
    v_mov_b32 v199, 0
    v_mov_b32 v200, 0
    v_mov_b32 v201, 0
    v_mov_b32 v202, 0
    v_mov_b32 v203, 0
    v_mov_b32 v204, 0
    v_mov_b32 v205, 0
    v_mov_b32 v206, 0
    v_mov_b32 v207, 0
    v_mov_b32 v208, 0
    v_mov_b32 v209, 0
    v_mov_b32 v210, 0
    v_mov_b32 v211, 0
    s_waitcnt lgkmcnt(0)
    s_mov_b32 s32, s16
    s_and_b32 s33, s17, 0xffff
    s_mov_b32 s34, 18874368
    s_mov_b32 s35, 0x00020000
    s_or_b32 s56, s2, s42
    s_cmp_lg_u32 s56, 0
    s_cbranch_scc1 L_k1_nz
    v_lshlrev_b32 v4, 7, v1
    s_mov_b32 s56, 11665408
    s_mov_b32 s57, 11673600
    buffer_store_dword v128, v4, s[32:35], s56 offen sc1
    buffer_store_dword v128, v4, s[32:35], s57 offen sc1
L_k1_nz:
    s_lshr_b32 s56, s41, 2
    s_cmp_eq_u32 s56, 2
    s_cbranch_scc1 L_k1_vtype
    s_cmp_eq_u32 s56, 1
    s_mov_b32 s61, 81920
    s_cmov_b32 s61, 166400
    s_mov_b32 s62, 1280
    s_cmov_b32 s62, 2560
    s_cselect_b32 s64, 1.0, 0x3ea52b5c
    s_cselect_b32 s65, 1.0, 0x3ea52b5c
    s_cselect_b32 s60, 5242880, 0
    s_mov_b32 s63, 10747904
    s_cmov_b32 s63, 11272192
    s_cselect_b32 s59, 9, 13
    s_lshl_b32 s57, s45, 3
    s_cmp_eq_u32 s56, 3
    s_cselect_b32 s58, 32, 0
    s_add_u32 s57, s57, s58
    s_lshl_b32 s58, s44, 2
    s_add_u32 s57, s57, s58
    s_mul_i32 s58, s57, s61
    s_add_u32 s60, s60, s58
    s_lshl_b32 s58, s57, s59
    s_add_u32 s63, s63, s58
    v_lshrrev_b32 v4, 1, v3
    v_lshlrev_b32 v4, 9, v4
    v_and_b32 v5, 1, v3
    v_lshlrev_b32 v6, 4, v2
    v_add_u32 v4, v4, v6
    v_lshl_add_u32 v38, v5, 3, v4
    v_mul_lo_u32 v5, v5, s61
    v_add_u32 v42, v4, v5
    v_mul_lo_u32 v4, v3, s61
    v_lshl_add_u32 v39, v2, 3, v4
    v_lshlrev_b32 v41, 9, v3
    s_lshl_b32 s61, s61, 1
    v_add_u32 v40, s61, v42
    s_lshr_b32 s56, s66, 1
    s_lshl_b32 s57, s40, 2
    s_add_u32 s59, s56, s57
    s_mul_i32 s56, s59, s62
    s_add_u32 s56, s56, s60
    s_and_b32 s57, s66, 1
    s_lshl_b32 s58, s57, 8
    s_add_u32 s4, s56, s58
    s_lshl_b32 s57, s57, 7
    s_add_u32 s8, s56, s57
    s_add_u32 s8, s8, 1024
    s_mul_i32 s56, s59, 2560
    s_add_u32 s56, s56, 10567680
    s_add_u32 s20, s56, s58
    s_add_u32 s21, s56, s57
    s_add_u32 s21, s21, 1024
    s_lshl_b32 s58, s40, 3
    s_add_u32 s58, s58, s66
    s_lshl_b32 s58, s58, 2
    s_lshl_b32 s59, s58, 4
    s_cmp_eq_u32 s62, 2560
    s_cselect_b32 s59, s58, s59
    s_add_u32 s12, s59, s63
    s_lshl_b32 s59, s44, 9
    s_add_u32 s22, s58, s59
    s_add_u32 s22, s22, 11288576
    s_lshr_b32 s56, s67, 1
    s_lshl_b32 s57, s40, 2
    s_add_u32 s59, s56, s57
    s_mul_i32 s56, s59, s62
    s_add_u32 s56, s56, s60
    s_and_b32 s57, s67, 1
    s_lshl_b32 s58, s57, 8
    s_add_u32 s5, s56, s58
    s_lshl_b32 s57, s57, 7
    s_add_u32 s9, s56, s57
    s_add_u32 s9, s9, 1024
    s_lshl_b32 s58, s40, 3
    s_add_u32 s58, s58, s67
    s_lshl_b32 s58, s58, 2
    s_lshl_b32 s59, s58, 4
    s_cmp_eq_u32 s62, 2560
    s_cselect_b32 s59, s58, s59
    s_add_u32 s13, s59, s63
    s_lshr_b32 s56, s68, 1
    s_lshl_b32 s57, s40, 2
    s_add_u32 s59, s56, s57
    s_mul_i32 s56, s59, s62
    s_add_u32 s56, s56, s60
    s_and_b32 s57, s68, 1
    s_lshl_b32 s58, s57, 8
    s_add_u32 s6, s56, s58
    s_lshl_b32 s57, s57, 7
    s_add_u32 s10, s56, s57
    s_add_u32 s10, s10, 1024
    s_lshl_b32 s58, s40, 3
    s_add_u32 s58, s58, s68
    s_lshl_b32 s58, s58, 2
    s_lshl_b32 s59, s58, 4
    s_cmp_eq_u32 s62, 2560
    s_cselect_b32 s59, s58, s59
    s_add_u32 s14, s59, s63
    s_lshr_b32 s56, s69, 1
    s_lshl_b32 s57, s40, 2
    s_add_u32 s59, s56, s57
    s_mul_i32 s56, s59, s62
    s_add_u32 s56, s56, s60
    s_and_b32 s57, s69, 1
    s_lshl_b32 s58, s57, 8
    s_add_u32 s7, s56, s58
    s_lshl_b32 s57, s57, 7
    s_add_u32 s11, s56, s57
    s_add_u32 s11, s11, 1024
    s_lshl_b32 s58, s40, 3
    s_add_u32 s58, s58, s69
    s_lshl_b32 s58, s58, 2
    s_lshl_b32 s59, s58, 4
    s_cmp_eq_u32 s62, 2560
    s_cselect_b32 s59, s58, s59
    s_add_u32 s15, s59, s63
    s_barrier
    ds_read_b128 v[48:51], v26 offset:0
    ds_read_b128 v[52:55], v26 offset:2048
    ds_read_b128 v[56:59], v26 offset:4096
    ds_read_b128 v[60:63], v26 offset:6144
    ds_read_b64_tr_b16 v[64:65], v28 offset:0
    ds_read_b64_tr_b16 v[66:67], v28 offset:2560
    ds_read_b64_tr_b16 v[68:69], v28 offset:40
    ds_read_b64_tr_b16 v[70:71], v28 offset:2600
    ds_read_b64_tr_b16 v[72:73], v28 offset:80
    ds_read_b64_tr_b16 v[74:75], v28 offset:2640
    ds_read_b64_tr_b16 v[76:77], v28 offset:120
    ds_read_b64_tr_b16 v[78:79], v28 offset:2680
    ds_read_b64_tr_b16 v[80:81], v29 offset:0
    ds_read_b64_tr_b16 v[82:83], v29 offset:2560
    ds_read_b64_tr_b16 v[84:85], v30 offset:0
    ds_read_b64_tr_b16 v[86:87], v30 offset:160
    s_mov_b32 s79, 0
.p2align 6
L_k1_loop_q:
    s_and_b32 s56, s79, 3
    s_cmp_eq_u32 s56, 3
    s_mov_b32 s53, 39424
    s_cmov_b32 s53, 4294849024
    s_add_u32 s79, s79, 1
    s_waitcnt lgkmcnt(0)
    v_mfma_f32_16x16x32_bf16 v[128:131], v[64:67], v[48:51], v[128:131]
    ds_read_b128 v[88:91], v27 offset:0
    v_mfma_f32_16x16x32_bf16 v[148:151], v[64:67], v[52:55], v[148:151]
    ds_read_b128 v[92:95], v27 offset:2048
    v_mfma_f32_16x16x32_bf16 v[168:171], v[64:67], v[56:59], v[168:171]
    ds_read_b128 v[96:99], v27 offset:4096
    v_mfma_f32_16x16x32_bf16 v[188:191], v[64:67], v[60:63], v[188:191]
    ds_read_b128 v[100:103], v27 offset:6144
    v_mfma_f32_16x16x32_bf16 v[132:135], v[68:71], v[48:51], v[132:135]
    ds_read_b64_tr_b16 v[104:105], v28 offset:5120
    v_mfma_f32_16x16x32_bf16 v[152:155], v[68:71], v[52:55], v[152:155]
    ds_read_b64_tr_b16 v[106:107], v28 offset:7680
    v_mfma_f32_16x16x32_bf16 v[172:175], v[68:71], v[56:59], v[172:175]
    ds_read_b64_tr_b16 v[108:109], v28 offset:5160
    v_mfma_f32_16x16x32_bf16 v[192:195], v[68:71], v[60:63], v[192:195]
    ds_read_b64_tr_b16 v[110:111], v28 offset:7720
    v_mfma_f32_16x16x32_bf16 v[136:139], v[72:75], v[48:51], v[136:139]
    ds_read_b64_tr_b16 v[112:113], v28 offset:5200
    v_mfma_f32_16x16x32_bf16 v[156:159], v[72:75], v[52:55], v[156:159]
    ds_read_b64_tr_b16 v[114:115], v28 offset:7760
    v_mfma_f32_16x16x32_bf16 v[176:179], v[72:75], v[56:59], v[176:179]
    ds_read_b64_tr_b16 v[116:117], v28 offset:5240
    v_mfma_f32_16x16x32_bf16 v[196:199], v[72:75], v[60:63], v[196:199]
    ds_read_b64_tr_b16 v[118:119], v28 offset:7800
    v_mfma_f32_16x16x32_bf16 v[140:143], v[76:79], v[48:51], v[140:143]
    ds_read_b64_tr_b16 v[120:121], v29 offset:5120
    v_mfma_f32_16x16x32_bf16 v[160:163], v[76:79], v[52:55], v[160:163]
    ds_read_b64_tr_b16 v[122:123], v29 offset:7680
    v_mfma_f32_16x16x32_bf16 v[180:183], v[76:79], v[56:59], v[180:183]
    ds_read_b64_tr_b16 v[124:125], v30 offset:1280
    v_mfma_f32_16x16x32_bf16 v[200:203], v[76:79], v[60:63], v[200:203]
    ds_read_b64_tr_b16 v[126:127], v30 offset:1440
    v_mfma_f32_16x16x32_bf16 v[144:147], v[80:83], v[48:51], v[144:147]
    v_add_u32 v26, s53, v26
    v_mfma_f32_16x16x32_bf16 v[164:167], v[80:83], v[52:55], v[164:167]
    v_add_u32 v27, s53, v27
    v_mfma_f32_16x16x32_bf16 v[184:187], v[80:83], v[56:59], v[184:187]
    v_add_u32 v28, s53, v28
    v_mfma_f32_16x16x32_bf16 v[204:207], v[80:83], v[60:63], v[204:207]
    v_add_u32 v30, s53, v30
    v_mfma_f32_16x16x32_bf16 v[208:211], v[84:87], v[48:51], v[208:211]
    v_add_u32 v29, s53, v29
    s_waitcnt lgkmcnt(0)
    s_barrier
    v_mfma_f32_16x16x32_bf16 v[128:131], v[104:107], v[88:91], v[128:131]
    ds_read_b128 v[48:51], v26 offset:0
    v_mfma_f32_16x16x32_bf16 v[148:151], v[104:107], v[92:95], v[148:151]
    ds_read_b128 v[52:55], v26 offset:2048
    v_mfma_f32_16x16x32_bf16 v[168:171], v[104:107], v[96:99], v[168:171]
    ds_read_b128 v[56:59], v26 offset:4096
    v_mfma_f32_16x16x32_bf16 v[188:191], v[104:107], v[100:103], v[188:191]
    ds_read_b128 v[60:63], v26 offset:6144
    v_mfma_f32_16x16x32_bf16 v[132:135], v[108:111], v[88:91], v[132:135]
    ds_read_b64_tr_b16 v[64:65], v28 offset:0
    v_mfma_f32_16x16x32_bf16 v[152:155], v[108:111], v[92:95], v[152:155]
    ds_read_b64_tr_b16 v[66:67], v28 offset:2560
    v_mfma_f32_16x16x32_bf16 v[172:175], v[108:111], v[96:99], v[172:175]
    ds_read_b64_tr_b16 v[68:69], v28 offset:40
    v_mfma_f32_16x16x32_bf16 v[192:195], v[108:111], v[100:103], v[192:195]
    ds_read_b64_tr_b16 v[70:71], v28 offset:2600
    v_mfma_f32_16x16x32_bf16 v[136:139], v[112:115], v[88:91], v[136:139]
    ds_read_b64_tr_b16 v[72:73], v28 offset:80
    v_mfma_f32_16x16x32_bf16 v[156:159], v[112:115], v[92:95], v[156:159]
    ds_read_b64_tr_b16 v[74:75], v28 offset:2640
    v_mfma_f32_16x16x32_bf16 v[176:179], v[112:115], v[96:99], v[176:179]
    ds_read_b64_tr_b16 v[76:77], v28 offset:120
    v_mfma_f32_16x16x32_bf16 v[196:199], v[112:115], v[100:103], v[196:199]
    ds_read_b64_tr_b16 v[78:79], v28 offset:2680
    v_mfma_f32_16x16x32_bf16 v[140:143], v[116:119], v[88:91], v[140:143]
    ds_read_b64_tr_b16 v[80:81], v29 offset:0
    v_mfma_f32_16x16x32_bf16 v[160:163], v[116:119], v[92:95], v[160:163]
    ds_read_b64_tr_b16 v[82:83], v29 offset:2560
    v_mfma_f32_16x16x32_bf16 v[180:183], v[116:119], v[96:99], v[180:183]
    ds_read_b64_tr_b16 v[84:85], v30 offset:0
    v_mfma_f32_16x16x32_bf16 v[200:203], v[116:119], v[100:103], v[200:203]
    ds_read_b64_tr_b16 v[86:87], v30 offset:160
    v_mfma_f32_16x16x32_bf16 v[144:147], v[120:123], v[88:91], v[144:147]
    v_mfma_f32_16x16x32_bf16 v[164:167], v[120:123], v[92:95], v[164:167]
    v_mfma_f32_16x16x32_bf16 v[184:187], v[120:123], v[96:99], v[184:187]
    v_mfma_f32_16x16x32_bf16 v[204:207], v[120:123], v[100:103], v[204:207]
    v_mfma_f32_16x16x32_bf16 v[208:211], v[124:127], v[88:91], v[208:211]
    s_cmp_lt_u32 s79, 10
    s_cbranch_scc1 L_k1_loop_q
    s_nop 7
    s_cmp_eq_u32 s62, 2560
    v_pk_mul_f32 v[128:129], v[128:129], s[64:65]
    v_pk_mul_f32 v[130:131], v[130:131], s[64:65]
    v_pk_mul_f32 v[132:133], v[132:133], s[64:65]
    v_pk_mul_f32 v[134:135], v[134:135], s[64:65]
    v_pk_mul_f32 v[136:137], v[136:137], s[64:65]
    v_pk_mul_f32 v[138:139], v[138:139], s[64:65]
    v_pk_mul_f32 v[140:141], v[140:141], s[64:65]
    v_pk_mul_f32 v[142:143], v[142:143], s[64:65]
    v_pk_mul_f32 v[144:145], v[144:145], s[64:65]
    v_pk_mul_f32 v[146:147], v[146:147], s[64:65]
    v_cvt_pk_bf16_f32 v128, v128, v129
    v_cvt_pk_bf16_f32 v129, v130, v131
    v_cvt_pk_bf16_f32 v130, v132, v133
    v_cvt_pk_bf16_f32 v131, v134, v135
    v_cvt_pk_bf16_f32 v136, v136, v137
    v_cvt_pk_bf16_f32 v137, v138, v139
    v_cvt_pk_bf16_f32 v138, v140, v141
    v_cvt_pk_bf16_f32 v139, v142, v143
    v_cvt_pk_bf16_f32 v144, v144, v145
    v_cvt_pk_bf16_f32 v145, v146, v147
    s_cbranch_scc0 L_k1_nn0
    v_dot2_f32_bf16 v2, v128, v128, 0
    v_dot2_f32_bf16 v3, v130, v130, 0
    v_dot2_f32_bf16 v4, v136, v136, 0
    v_dot2_f32_bf16 v5, v138, v138, 0
    v_dot2_f32_bf16 v6, v144, v144, 0
    v_dot2_f32_bf16 v2, v129, v129, v2
    v_dot2_f32_bf16 v3, v131, v131, v3
    v_dot2_f32_bf16 v4, v137, v137, v4
    v_dot2_f32_bf16 v5, v139, v139, v5
    v_dot2_f32_bf16 v6, v145, v145, v6
    s_nop 2
    v_permlane16_swap_b32 v2, v3
    v_permlane16_swap_b32 v4, v5
    v_add_f32 v2, v2, v3
    v_add_f32 v4, v4, v5
    s_nop 1
    v_permlane32_swap_b32 v2, v4
    v_add_f32 v2, v2, v4
    v_add_f32 v8, v2, v6
L_k1_nn0:
    buffer_store_dwordx2 v[144:145], v39, s[32:35], s8 offen sc1
    v_permlane16_swap_b32 v128, v130
    v_permlane16_swap_b32 v129, v131
    buffer_store_dwordx4 v[128:131], v42, s[32:35], s4 offen sc1
    v_permlane16_swap_b32 v136, v138
    v_permlane16_swap_b32 v137, v139
    buffer_store_dwordx4 v[136:139], v40, s[32:35], s4 offen sc1
    v_pk_mul_f32 v[148:149], v[148:149], s[64:65]
    v_pk_mul_f32 v[150:151], v[150:151], s[64:65]
    v_pk_mul_f32 v[152:153], v[152:153], s[64:65]
    v_pk_mul_f32 v[154:155], v[154:155], s[64:65]
    v_pk_mul_f32 v[156:157], v[156:157], s[64:65]
    v_pk_mul_f32 v[158:159], v[158:159], s[64:65]
    v_pk_mul_f32 v[160:161], v[160:161], s[64:65]
    v_pk_mul_f32 v[162:163], v[162:163], s[64:65]
    v_pk_mul_f32 v[164:165], v[164:165], s[64:65]
    v_pk_mul_f32 v[166:167], v[166:167], s[64:65]
    v_cvt_pk_bf16_f32 v148, v148, v149
    v_cvt_pk_bf16_f32 v149, v150, v151
    v_cvt_pk_bf16_f32 v150, v152, v153
    v_cvt_pk_bf16_f32 v151, v154, v155
    v_cvt_pk_bf16_f32 v156, v156, v157
    v_cvt_pk_bf16_f32 v157, v158, v159
    v_cvt_pk_bf16_f32 v158, v160, v161
    v_cvt_pk_bf16_f32 v159, v162, v163
    v_cvt_pk_bf16_f32 v164, v164, v165
    v_cvt_pk_bf16_f32 v165, v166, v167
    s_cbranch_scc0 L_k1_nn1
    v_dot2_f32_bf16 v2, v148, v148, 0
    v_dot2_f32_bf16 v3, v150, v150, 0
    v_dot2_f32_bf16 v4, v156, v156, 0
    v_dot2_f32_bf16 v5, v158, v158, 0
    v_dot2_f32_bf16 v6, v164, v164, 0
    v_dot2_f32_bf16 v2, v149, v149, v2
    v_dot2_f32_bf16 v3, v151, v151, v3
    v_dot2_f32_bf16 v4, v157, v157, v4
    v_dot2_f32_bf16 v5, v159, v159, v5
    v_dot2_f32_bf16 v6, v165, v165, v6
    s_nop 2
    v_permlane16_swap_b32 v2, v3
    v_permlane16_swap_b32 v4, v5
    v_add_f32 v2, v2, v3
    v_add_f32 v4, v4, v5
    s_nop 1
    v_permlane32_swap_b32 v2, v4
    v_add_f32 v2, v2, v4
    v_add_f32 v9, v2, v6
L_k1_nn1:
    buffer_store_dwordx2 v[164:165], v39, s[32:35], s9 offen sc1
    v_permlane16_swap_b32 v148, v150
    v_permlane16_swap_b32 v149, v151
    buffer_store_dwordx4 v[148:151], v42, s[32:35], s5 offen sc1
    v_permlane16_swap_b32 v156, v158
    v_permlane16_swap_b32 v157, v159
    buffer_store_dwordx4 v[156:159], v40, s[32:35], s5 offen sc1
    v_pk_mul_f32 v[168:169], v[168:169], s[64:65]
    v_pk_mul_f32 v[170:171], v[170:171], s[64:65]
    v_pk_mul_f32 v[172:173], v[172:173], s[64:65]
    v_pk_mul_f32 v[174:175], v[174:175], s[64:65]
    v_pk_mul_f32 v[176:177], v[176:177], s[64:65]
    v_pk_mul_f32 v[178:179], v[178:179], s[64:65]
    v_pk_mul_f32 v[180:181], v[180:181], s[64:65]
    v_pk_mul_f32 v[182:183], v[182:183], s[64:65]
    v_pk_mul_f32 v[184:185], v[184:185], s[64:65]
    v_pk_mul_f32 v[186:187], v[186:187], s[64:65]
    v_cvt_pk_bf16_f32 v168, v168, v169
    v_cvt_pk_bf16_f32 v169, v170, v171
    v_cvt_pk_bf16_f32 v170, v172, v173
    v_cvt_pk_bf16_f32 v171, v174, v175
    v_cvt_pk_bf16_f32 v176, v176, v177
    v_cvt_pk_bf16_f32 v177, v178, v179
    v_cvt_pk_bf16_f32 v178, v180, v181
    v_cvt_pk_bf16_f32 v179, v182, v183
    v_cvt_pk_bf16_f32 v184, v184, v185
    v_cvt_pk_bf16_f32 v185, v186, v187
    s_cbranch_scc0 L_k1_nn2
    v_dot2_f32_bf16 v2, v168, v168, 0
    v_dot2_f32_bf16 v3, v170, v170, 0
    v_dot2_f32_bf16 v4, v176, v176, 0
    v_dot2_f32_bf16 v5, v178, v178, 0
    v_dot2_f32_bf16 v6, v184, v184, 0
    v_dot2_f32_bf16 v2, v169, v169, v2
    v_dot2_f32_bf16 v3, v171, v171, v3
    v_dot2_f32_bf16 v4, v177, v177, v4
    v_dot2_f32_bf16 v5, v179, v179, v5
    v_dot2_f32_bf16 v6, v185, v185, v6
    s_nop 2
    v_permlane16_swap_b32 v2, v3
    v_permlane16_swap_b32 v4, v5
    v_add_f32 v2, v2, v3
    v_add_f32 v4, v4, v5
    s_nop 1
    v_permlane32_swap_b32 v2, v4
    v_add_f32 v2, v2, v4
    v_add_f32 v10, v2, v6
L_k1_nn2:
    buffer_store_dwordx2 v[184:185], v39, s[32:35], s10 offen sc1
    v_permlane16_swap_b32 v168, v170
    v_permlane16_swap_b32 v169, v171
    buffer_store_dwordx4 v[168:171], v42, s[32:35], s6 offen sc1
    v_permlane16_swap_b32 v176, v178
    v_permlane16_swap_b32 v177, v179
    buffer_store_dwordx4 v[176:179], v40, s[32:35], s6 offen sc1
    v_pk_mul_f32 v[188:189], v[188:189], s[64:65]
    v_pk_mul_f32 v[190:191], v[190:191], s[64:65]
    v_pk_mul_f32 v[192:193], v[192:193], s[64:65]
    v_pk_mul_f32 v[194:195], v[194:195], s[64:65]
    v_pk_mul_f32 v[196:197], v[196:197], s[64:65]
    v_pk_mul_f32 v[198:199], v[198:199], s[64:65]
    v_pk_mul_f32 v[200:201], v[200:201], s[64:65]
    v_pk_mul_f32 v[202:203], v[202:203], s[64:65]
    v_pk_mul_f32 v[204:205], v[204:205], s[64:65]
    v_pk_mul_f32 v[206:207], v[206:207], s[64:65]
    v_cvt_pk_bf16_f32 v188, v188, v189
    v_cvt_pk_bf16_f32 v189, v190, v191
    v_cvt_pk_bf16_f32 v190, v192, v193
    v_cvt_pk_bf16_f32 v191, v194, v195
    v_cvt_pk_bf16_f32 v196, v196, v197
    v_cvt_pk_bf16_f32 v197, v198, v199
    v_cvt_pk_bf16_f32 v198, v200, v201
    v_cvt_pk_bf16_f32 v199, v202, v203
    v_cvt_pk_bf16_f32 v204, v204, v205
    v_cvt_pk_bf16_f32 v205, v206, v207
    s_cbranch_scc0 L_k1_nn3
    v_dot2_f32_bf16 v2, v188, v188, 0
    v_dot2_f32_bf16 v3, v190, v190, 0
    v_dot2_f32_bf16 v4, v196, v196, 0
    v_dot2_f32_bf16 v5, v198, v198, 0
    v_dot2_f32_bf16 v6, v204, v204, 0
    v_dot2_f32_bf16 v2, v189, v189, v2
    v_dot2_f32_bf16 v3, v191, v191, v3
    v_dot2_f32_bf16 v4, v197, v197, v4
    v_dot2_f32_bf16 v5, v199, v199, v5
    v_dot2_f32_bf16 v6, v205, v205, v6
    s_nop 2
    v_permlane16_swap_b32 v2, v3
    v_permlane16_swap_b32 v4, v5
    v_add_f32 v2, v2, v3
    v_add_f32 v4, v4, v5
    s_nop 1
    v_permlane32_swap_b32 v2, v4
    v_add_f32 v2, v2, v4
    v_add_f32 v11, v2, v6
L_k1_nn3:
    buffer_store_dwordx2 v[204:205], v39, s[32:35], s11 offen sc1
    v_permlane16_swap_b32 v188, v190
    v_permlane16_swap_b32 v189, v191
    buffer_store_dwordx4 v[188:191], v42, s[32:35], s7 offen sc1
    v_permlane16_swap_b32 v196, v198
    v_permlane16_swap_b32 v197, v199
    buffer_store_dwordx4 v[196:199], v40, s[32:35], s7 offen sc1
    s_cbranch_scc1 L_k1_kn
    s_cmp_ge_u32 s41, 4
    s_cbranch_scc1 L_k1_done
    v_cvt_pk_bf16_f32 v208, v208, v209
    v_cvt_pk_bf16_f32 v209, v210, v211
    v_dot2_f32_bf16 v2, v208, v208, 0
    v_dot2_f32_bf16 v2, v209, v209, v2
    s_cmp_eq_u32 s44, 1
    s_cbranch_scc1 L_k1_kb1
    buffer_store_dwordx2 v[208:209], v38, s[32:35], s20 offen sc1
    s_nop 0
    v_mov_b32 v3, v2
    s_nop 1
    v_permlane16_swap_b32 v2, v3
    v_add_f32 v2, v2, v3
    v_mov_b32 v3, v2
    s_nop 1
    v_permlane32_swap_b32 v2, v3
    v_add_f32 v2, v2, v3
    s_branch L_k1_kb2
L_k1_kb1:
    s_mov_b64 exec, s[72:73]
    buffer_store_dwordx2 v[208:209], v39, s[32:35], s21 offen sc1
    s_mov_b64 exec, -1
L_k1_kb2:
    s_nop 1
    v_max_f32_dpp v2, v2, v2 row_ror:8 row_mask:0xf bank_mask:0xf
    s_nop 1
    v_max_f32_dpp v2, v2, v2 row_ror:4 row_mask:0xf bank_mask:0xf
    s_nop 1
    v_max_f32_dpp v2, v2, v2 row_ror:2 row_mask:0xf bank_mask:0xf
    s_nop 1
    v_max_f32_dpp v2, v2, v2 row_ror:1 row_mask:0xf bank_mask:0xf
    s_mov_b64 exec, 1
    buffer_store_dword v2, v41, s[32:35], s22 offen sc1
    s_branch L_k1_done
L_k1_kn:
    v_max_f32_dpp v8, v8, v8 row_ror:8 row_mask:0xf bank_mask:0xf
    v_max_f32_dpp v9, v9, v9 row_ror:8 row_mask:0xf bank_mask:0xf
    v_max_f32_dpp v10, v10, v10 row_ror:8 row_mask:0xf bank_mask:0xf
    v_max_f32_dpp v11, v11, v11 row_ror:8 row_mask:0xf bank_mask:0xf
    v_max_f32_dpp v8, v8, v8 row_ror:4 row_mask:0xf bank_mask:0xf
    v_max_f32_dpp v9, v9, v9 row_ror:4 row_mask:0xf bank_mask:0xf
    v_max_f32_dpp v10, v10, v10 row_ror:4 row_mask:0xf bank_mask:0xf
    v_max_f32_dpp v11, v11, v11 row_ror:4 row_mask:0xf bank_mask:0xf
    v_max_f32_dpp v8, v8, v8 row_ror:2 row_mask:0xf bank_mask:0xf
    v_max_f32_dpp v9, v9, v9 row_ror:2 row_mask:0xf bank_mask:0xf
    v_max_f32_dpp v10, v10, v10 row_ror:2 row_mask:0xf bank_mask:0xf
    v_max_f32_dpp v11, v11, v11 row_ror:2 row_mask:0xf bank_mask:0xf
    v_max_f32_dpp v8, v8, v8 row_ror:1 row_mask:0xf bank_mask:0xf
    v_max_f32_dpp v9, v9, v9 row_ror:1 row_mask:0xf bank_mask:0xf
    v_max_f32_dpp v10, v10, v10 row_ror:1 row_mask:0xf bank_mask:0xf
    v_max_f32_dpp v11, v11, v11 row_ror:1 row_mask:0xf bank_mask:0xf
    s_mov_b64 exec, s[74:75]
    buffer_store_dword v8, v41, s[32:35], s12 offen sc1
    buffer_store_dword v9, v41, s[32:35], s13 offen sc1
    buffer_store_dword v10, v41, s[32:35], s14 offen sc1
    buffer_store_dword v11, v41, s[32:35], s15 offen sc1
    s_branch L_k1_done
L_k1_vtype:
    v_and_b32 v4, 1, v3
    v_mul_u32_u24 v4, 320, v4
    v_lshrrev_b32 v5, 1, v3
    s_mov_b32 s61, 166400
    v_lshlrev_b32 v8, 4, v5
    v_lshl_add_u32 v9, v5, 3, v4
    v_add_u32 v5, 0, v2
    v_add_u32 v5, v5, v8
    v_mul_u32_u24 v6, 205, v5
    v_lshrrev_b32 v6, 12, v6
    v_mul_u32_u24 v7, 20, v6
    v_sub_u32 v7, v5, v7
    v_mul_lo_u32 v6, v6, s61
    v_lshlrev_b32 v7, 4, v7
    v_add3_u32 v43, v6, v7, v4
    v_add_u32 v5, 32, v2
    v_add_u32 v5, v5, v8
    v_mul_u32_u24 v6, 205, v5
    v_lshrrev_b32 v6, 12, v6
    v_mul_u32_u24 v7, 20, v6
    v_sub_u32 v7, v5, v7
    v_mul_lo_u32 v6, v6, s61
    v_lshlrev_b32 v7, 4, v7
    v_add3_u32 v44, v6, v7, v4
    v_add_u32 v5, 64, v2
    v_mul_u32_u24 v6, 205, v5
    v_lshrrev_b32 v6, 12, v6
    v_mul_u32_u24 v7, 20, v6
    v_sub_u32 v7, v5, v7
    v_mul_lo_u32 v6, v6, s61
    v_lshlrev_b32 v7, 4, v7
    v_add3_u32 v45, v6, v7, v9
    s_lshl_b32 s56, s44, 4
    v_add_u32 v5, s56, v2
    v_cmp_gt_u32 s[64:65], 20, v5
    v_lshl_add_u32 v46, v5, 4, v9
    s_lshl_b32 s57, s45, 3
    s_lshl_b32 s58, s44, 2
    s_add_u32 s57, s57, s58
    s_mul_i32 s60, s57, s61
    s_add_u32 s60, s60, 5246720
    s_lshr_b32 s56, s66, 1
    s_lshl_b32 s57, s40, 2
    s_add_u32 s56, s56, s57
    s_mul_i32 s56, s56, 2560
    s_and_b32 s57, s66, 1
    s_mul_i32 s57, s57, 640
    s_add_u32 s56, s56, s57
    s_add_u32 s4, s56, s60
    s_add_u32 s21, s56, 10571520
    s_lshr_b32 s56, s67, 1
    s_lshl_b32 s57, s40, 2
    s_add_u32 s56, s56, s57
    s_mul_i32 s56, s56, 2560
    s_and_b32 s57, s67, 1
    s_mul_i32 s57, s57, 640
    s_add_u32 s56, s56, s57
    s_add_u32 s5, s56, s60
    s_lshr_b32 s56, s68, 1
    s_lshl_b32 s57, s40, 2
    s_add_u32 s56, s56, s57
    s_mul_i32 s56, s56, 2560
    s_and_b32 s57, s68, 1
    s_mul_i32 s57, s57, 640
    s_add_u32 s56, s56, s57
    s_add_u32 s6, s56, s60
    s_lshr_b32 s56, s69, 1
    s_lshl_b32 s57, s40, 2
    s_add_u32 s56, s56, s57
    s_mul_i32 s56, s56, 2560
    s_and_b32 s57, s69, 1
    s_mul_i32 s57, s57, 640
    s_add_u32 s56, s56, s57
    s_add_u32 s7, s56, s60
    s_barrier
    ds_read_b128 v[48:51], v26 offset:0
    ds_read_b128 v[52:55], v26 offset:2048
    ds_read_b128 v[56:59], v26 offset:4096
    ds_read_b128 v[60:63], v26 offset:6144
    ds_read_b64_tr_b16 v[64:65], v28 offset:0
    ds_read_b64_tr_b16 v[66:67], v28 offset:2560
    ds_read_b64_tr_b16 v[68:69], v28 offset:32
    ds_read_b64_tr_b16 v[70:71], v28 offset:2592
    ds_read_b64_tr_b16 v[72:73], v28 offset:64
    ds_read_b64_tr_b16 v[74:75], v28 offset:2624
    ds_read_b64_tr_b16 v[76:77], v28 offset:96
    ds_read_b64_tr_b16 v[78:79], v28 offset:2656
    ds_read_b64_tr_b16 v[80:81], v28 offset:128
    ds_read_b64_tr_b16 v[82:83], v28 offset:2688
    ds_read_b64_tr_b16 v[84:85], v30 offset:0
    ds_read_b64_tr_b16 v[86:87], v30 offset:160
    s_mov_b32 s79, 0
.p2align 6
L_k1_loop_v:
    s_and_b32 s56, s79, 3
    s_cmp_eq_u32 s56, 3
    s_mov_b32 s53, 39424
    s_cmov_b32 s53, 4294849024
    s_add_u32 s79, s79, 1
    s_waitcnt lgkmcnt(0)
    v_mfma_f32_16x16x32_bf16 v[128:131], v[48:51], v[64:67], v[128:131]
    ds_read_b128 v[88:91], v27 offset:0
    v_mfma_f32_16x16x32_bf16 v[148:151], v[52:55], v[64:67], v[148:151]
    ds_read_b128 v[92:95], v27 offset:2048
    v_mfma_f32_16x16x32_bf16 v[168:171], v[56:59], v[64:67], v[168:171]
    ds_read_b128 v[96:99], v27 offset:4096
    v_mfma_f32_16x16x32_bf16 v[188:191], v[60:63], v[64:67], v[188:191]
    ds_read_b128 v[100:103], v27 offset:6144
    v_mfma_f32_16x16x32_bf16 v[132:135], v[48:51], v[68:71], v[132:135]
    ds_read_b64_tr_b16 v[104:105], v28 offset:5120
    v_mfma_f32_16x16x32_bf16 v[152:155], v[52:55], v[68:71], v[152:155]
    ds_read_b64_tr_b16 v[106:107], v28 offset:7680
    v_mfma_f32_16x16x32_bf16 v[172:175], v[56:59], v[68:71], v[172:175]
    ds_read_b64_tr_b16 v[108:109], v28 offset:5152
    v_mfma_f32_16x16x32_bf16 v[192:195], v[60:63], v[68:71], v[192:195]
    ds_read_b64_tr_b16 v[110:111], v28 offset:7712
    v_mfma_f32_16x16x32_bf16 v[136:139], v[48:51], v[72:75], v[136:139]
    ds_read_b64_tr_b16 v[112:113], v28 offset:5184
    v_mfma_f32_16x16x32_bf16 v[156:159], v[52:55], v[72:75], v[156:159]
    ds_read_b64_tr_b16 v[114:115], v28 offset:7744
    v_mfma_f32_16x16x32_bf16 v[176:179], v[56:59], v[72:75], v[176:179]
    ds_read_b64_tr_b16 v[116:117], v28 offset:5216
    v_mfma_f32_16x16x32_bf16 v[196:199], v[60:63], v[72:75], v[196:199]
    ds_read_b64_tr_b16 v[118:119], v28 offset:7776
    v_mfma_f32_16x16x32_bf16 v[140:143], v[48:51], v[76:79], v[140:143]
    ds_read_b64_tr_b16 v[120:121], v28 offset:5248
    v_mfma_f32_16x16x32_bf16 v[160:163], v[52:55], v[76:79], v[160:163]
    ds_read_b64_tr_b16 v[122:123], v28 offset:7808
    v_mfma_f32_16x16x32_bf16 v[180:183], v[56:59], v[76:79], v[180:183]
    ds_read_b64_tr_b16 v[124:125], v30 offset:1280
    v_mfma_f32_16x16x32_bf16 v[200:203], v[60:63], v[76:79], v[200:203]
    ds_read_b64_tr_b16 v[126:127], v30 offset:1440
    v_mfma_f32_16x16x32_bf16 v[144:147], v[48:51], v[80:83], v[144:147]
    v_add_u32 v26, s53, v26
    v_mfma_f32_16x16x32_bf16 v[164:167], v[52:55], v[80:83], v[164:167]
    v_add_u32 v27, s53, v27
    v_mfma_f32_16x16x32_bf16 v[184:187], v[56:59], v[80:83], v[184:187]
    v_add_u32 v28, s53, v28
    v_mfma_f32_16x16x32_bf16 v[204:207], v[60:63], v[80:83], v[204:207]
    v_add_u32 v30, s53, v30
    v_mfma_f32_16x16x32_bf16 v[208:211], v[48:51], v[84:87], v[208:211]
    s_waitcnt lgkmcnt(0)
    s_barrier
    v_mfma_f32_16x16x32_bf16 v[128:131], v[88:91], v[104:107], v[128:131]
    ds_read_b128 v[48:51], v26 offset:0
    v_mfma_f32_16x16x32_bf16 v[148:151], v[92:95], v[104:107], v[148:151]
    ds_read_b128 v[52:55], v26 offset:2048
    v_mfma_f32_16x16x32_bf16 v[168:171], v[96:99], v[104:107], v[168:171]
    ds_read_b128 v[56:59], v26 offset:4096
    v_mfma_f32_16x16x32_bf16 v[188:191], v[100:103], v[104:107], v[188:191]
    ds_read_b128 v[60:63], v26 offset:6144
    v_mfma_f32_16x16x32_bf16 v[132:135], v[88:91], v[108:111], v[132:135]
    ds_read_b64_tr_b16 v[64:65], v28 offset:0
    v_mfma_f32_16x16x32_bf16 v[152:155], v[92:95], v[108:111], v[152:155]
    ds_read_b64_tr_b16 v[66:67], v28 offset:2560
    v_mfma_f32_16x16x32_bf16 v[172:175], v[96:99], v[108:111], v[172:175]
    ds_read_b64_tr_b16 v[68:69], v28 offset:32
    v_mfma_f32_16x16x32_bf16 v[192:195], v[100:103], v[108:111], v[192:195]
    ds_read_b64_tr_b16 v[70:71], v28 offset:2592
    v_mfma_f32_16x16x32_bf16 v[136:139], v[88:91], v[112:115], v[136:139]
    ds_read_b64_tr_b16 v[72:73], v28 offset:64
    v_mfma_f32_16x16x32_bf16 v[156:159], v[92:95], v[112:115], v[156:159]
    ds_read_b64_tr_b16 v[74:75], v28 offset:2624
    v_mfma_f32_16x16x32_bf16 v[176:179], v[96:99], v[112:115], v[176:179]
    ds_read_b64_tr_b16 v[76:77], v28 offset:96
    v_mfma_f32_16x16x32_bf16 v[196:199], v[100:103], v[112:115], v[196:199]
    ds_read_b64_tr_b16 v[78:79], v28 offset:2656
    v_mfma_f32_16x16x32_bf16 v[140:143], v[88:91], v[116:119], v[140:143]
    ds_read_b64_tr_b16 v[80:81], v28 offset:128
    v_mfma_f32_16x16x32_bf16 v[160:163], v[92:95], v[116:119], v[160:163]
    ds_read_b64_tr_b16 v[82:83], v28 offset:2688
    v_mfma_f32_16x16x32_bf16 v[180:183], v[96:99], v[116:119], v[180:183]
    ds_read_b64_tr_b16 v[84:85], v30 offset:0
    v_mfma_f32_16x16x32_bf16 v[200:203], v[100:103], v[116:119], v[200:203]
    ds_read_b64_tr_b16 v[86:87], v30 offset:160
    v_mfma_f32_16x16x32_bf16 v[144:147], v[88:91], v[120:123], v[144:147]
    v_mfma_f32_16x16x32_bf16 v[164:167], v[92:95], v[120:123], v[164:167]
    v_mfma_f32_16x16x32_bf16 v[184:187], v[96:99], v[120:123], v[184:187]
    v_mfma_f32_16x16x32_bf16 v[204:207], v[100:103], v[120:123], v[204:207]
    v_mfma_f32_16x16x32_bf16 v[208:211], v[88:91], v[124:127], v[208:211]
    s_cmp_lt_u32 s79, 10
    s_cbranch_scc1 L_k1_loop_v
    s_nop 7
    v_cvt_pk_bf16_f32 v128, v128, v129
    v_cvt_pk_bf16_f32 v129, v130, v131
    v_cvt_pk_bf16_f32 v130, v132, v133
    v_cvt_pk_bf16_f32 v131, v134, v135
    v_cvt_pk_bf16_f32 v136, v136, v137
    v_cvt_pk_bf16_f32 v137, v138, v139
    v_cvt_pk_bf16_f32 v138, v140, v141
    v_cvt_pk_bf16_f32 v139, v142, v143
    v_cvt_pk_bf16_f32 v144, v144, v145
    v_cvt_pk_bf16_f32 v145, v146, v147
    buffer_store_dwordx2 v[144:145], v45, s[32:35], s4 offen sc1
    v_permlane32_swap_b32 v128, v130
    v_permlane32_swap_b32 v129, v131
    buffer_store_dwordx4 v[128:131], v43, s[32:35], s4 offen sc1
    v_permlane32_swap_b32 v136, v138
    v_permlane32_swap_b32 v137, v139
    buffer_store_dwordx4 v[136:139], v44, s[32:35], s4 offen sc1
    v_cvt_pk_bf16_f32 v148, v148, v149
    v_cvt_pk_bf16_f32 v149, v150, v151
    v_cvt_pk_bf16_f32 v150, v152, v153
    v_cvt_pk_bf16_f32 v151, v154, v155
    v_cvt_pk_bf16_f32 v156, v156, v157
    v_cvt_pk_bf16_f32 v157, v158, v159
    v_cvt_pk_bf16_f32 v158, v160, v161
    v_cvt_pk_bf16_f32 v159, v162, v163
    v_cvt_pk_bf16_f32 v164, v164, v165
    v_cvt_pk_bf16_f32 v165, v166, v167
    buffer_store_dwordx2 v[164:165], v45, s[32:35], s5 offen sc1
    v_permlane32_swap_b32 v148, v150
    v_permlane32_swap_b32 v149, v151
    buffer_store_dwordx4 v[148:151], v43, s[32:35], s5 offen sc1
    v_permlane32_swap_b32 v156, v158
    v_permlane32_swap_b32 v157, v159
    buffer_store_dwordx4 v[156:159], v44, s[32:35], s5 offen sc1
    v_cvt_pk_bf16_f32 v168, v168, v169
    v_cvt_pk_bf16_f32 v169, v170, v171
    v_cvt_pk_bf16_f32 v170, v172, v173
    v_cvt_pk_bf16_f32 v171, v174, v175
    v_cvt_pk_bf16_f32 v176, v176, v177
    v_cvt_pk_bf16_f32 v177, v178, v179
    v_cvt_pk_bf16_f32 v178, v180, v181
    v_cvt_pk_bf16_f32 v179, v182, v183
    v_cvt_pk_bf16_f32 v184, v184, v185
    v_cvt_pk_bf16_f32 v185, v186, v187
    buffer_store_dwordx2 v[184:185], v45, s[32:35], s6 offen sc1
    v_permlane32_swap_b32 v168, v170
    v_permlane32_swap_b32 v169, v171
    buffer_store_dwordx4 v[168:171], v43, s[32:35], s6 offen sc1
    v_permlane32_swap_b32 v176, v178
    v_permlane32_swap_b32 v177, v179
    buffer_store_dwordx4 v[176:179], v44, s[32:35], s6 offen sc1
    v_cvt_pk_bf16_f32 v188, v188, v189
    v_cvt_pk_bf16_f32 v189, v190, v191
    v_cvt_pk_bf16_f32 v190, v192, v193
    v_cvt_pk_bf16_f32 v191, v194, v195
    v_cvt_pk_bf16_f32 v196, v196, v197
    v_cvt_pk_bf16_f32 v197, v198, v199
    v_cvt_pk_bf16_f32 v198, v200, v201
    v_cvt_pk_bf16_f32 v199, v202, v203
    v_cvt_pk_bf16_f32 v204, v204, v205
    v_cvt_pk_bf16_f32 v205, v206, v207
    buffer_store_dwordx2 v[204:205], v45, s[32:35], s7 offen sc1
    v_permlane32_swap_b32 v188, v190
    v_permlane32_swap_b32 v189, v191
    buffer_store_dwordx4 v[188:191], v43, s[32:35], s7 offen sc1
    v_permlane32_swap_b32 v196, v198
    v_permlane32_swap_b32 v197, v199
    buffer_store_dwordx4 v[196:199], v44, s[32:35], s7 offen sc1
    v_cvt_pk_bf16_f32 v208, v208, v209
    v_cvt_pk_bf16_f32 v209, v210, v211
    s_mov_b64 exec, s[64:65]
    buffer_store_dwordx2 v[208:209], v46, s[32:35], s21 offen sc1
L_k1_done:
L_k1_exit:
    s_endpgm
.globl gmix_attn_kernel
.p2align 8
.type gmix_attn_kernel,@function
gmix_attn_kernel:
    s_cmp_ge_u32 s2, 256
    s_cbranch_scc1 L_k2_done
    s_load_dwordx2 s[4:5], s[0:1], 88
    s_load_dwordx2 s[6:7], s[0:1], 16
    s_load_dwordx2 s[40:41], s[0:1], 56
    s_load_dwordx2 s[42:43], s[0:1], 72
    v_lshrrev_b32 v10, 6, v0
    v_and_b32 v1, 63, v0
    s_and_b32 s54, s2, 7
    s_bfe_u32 s59, s2, 0x20003
    v_readfirstlane_b32 s12, v10
    s_bfe_u32 s13, s2, 0x10005
    s_lshl_b32 s17, s54, 2
    s_add_u32 s17, s17, s59
    s_lshr_b32 s21, s2, 6
    s_lshl_b32 s19, s13, 5
    s_add_u32 s15, s17, s19
    s_cmp_eq_u32 s13, 0
    s_cselect_b32 s20, s17, 32
    s_mul_i32 s14, s20, 166400
    s_add_u32 s14, s14, 5242880
    s_lshl_b32 s16, s21, 4
    s_lshl_b32 s17, s12, 1
    s_add_u32 s16, s16, s17
    s_mov_b32 s22, 0xfffff
    s_mov_b32 s23, 0xfffff
    s_mov_b32 s24, -1
    s_mov_b32 s25, 0
    s_mov_b32 s30, 0
    s_mul_i32 s31, s15, 81920
    s_mul_i32 s17, s16, 1280
    s_add_u32 s31, s31, s17
    s_add_u32 s31, s31, 0
    s_add_u32 s32, s31, 1280
    v_lshlrev_b32 v5, 4, v1
    v_and_b32 v10, 31, v1
    v_lshlrev_b32 v11, 3, v10
    v_add_u32 v11, 1024, v11
    v_lshlrev_b32 v12, 2, v10
    v_mov_b32 v20, 0
    v_mov_b32 v21, 0
    v_mov_b32 v28, 0
    v_mov_b32 v29, 0
    s_mul_i32 s27, s12, 5120
    s_add_u32 s33, s27, 40960
    s_xor_b32 s33, s33, s27
    s_add_u32 s28, s14, s27
    s_add_u32 s28, s28, 2560
    s_lshl_b32 s20, s20, 9
    s_add_u32 s20, s20, 11272192
    v_lshlrev_b32 v13, 3, v1
    v_mov_b32 v146, 0
    v_mov_b32 v147, 0
    s_lshl_b32 s18, s16, 7
    s_waitcnt lgkmcnt(0)
    s_mov_b32 s8, s4
    s_and_b32 s9, s5, 0xffff
    s_mov_b32 s10, 18874368
    s_mov_b32 s11, 0x00020000
    buffer_load_dwordx2 v[144:145], v13, s[8:11], s20 offen
    s_cmp_eq_u32 s13, 0
    s_cbranch_scc1 L_k2_non2
    buffer_load_dwordx2 v[146:147], v13, s[8:11], s20 offen offset:512
L_k2_non2:
    buffer_load_dwordx4 v[16:19], v5, s[8:11], s31 offen
    buffer_load_dwordx4 v[224:227], v5, s[8:11], s14 offen
    buffer_load_dwordx2 v[228:229], v11, s[8:11], s14 offen
    s_mov_b64 exec, s[24:25]
    buffer_load_dwordx2 v[20:21], v11, s[8:11], s31 offen
    buffer_load_dwordx2 v[28:29], v11, s[8:11], s32 offen
    s_mov_b64 exec, -1
    buffer_load_dwordx4 v[24:27], v5, s[8:11], s32 offen
    s_add_u32 m0, s27, 0
    s_mov_b32 s17, s28
    buffer_load_dwordx4 v5, s[8:11], s17 offen lds
    s_add_u32 m0, s27, 1024
    s_add_u32 s17, s28, 1024
    buffer_load_dwordx4 v5, s[8:11], s17 offen lds
    s_add_u32 m0, s27, 2048
    s_add_u32 s17, s28, 2048
    buffer_load_dwordx4 v5, s[8:11], s17 offen lds
    s_add_u32 m0, s27, 3072
    s_add_u32 s17, s28, 3072
    buffer_load_dwordx4 v5, s[8:11], s17 offen lds
    s_add_u32 m0, s27, 4096
    s_add_u32 s17, s28, 4096
    buffer_load_dwordx4 v5, s[8:11], s17 offen lds
    s_add_u32 s28, s28, 40960
    s_xor_b32 s27, s27, s33
    s_mov_b32 s58, s18
    v_lshlrev_b32 v2, 4, v1
    v_mov_b32 v3, v11
    v_lshrrev_b32 v13, 5, v1
    v_mul_u32_u24 v13, 320, v13
    v_lshlrev_b32 v4, 4, v10
    v_add3_u32 v4, v4, v13, 0
    v_add_u32 v4, 1280, v4
    s_mov_b32 s29, 40960
    s_mov_b32 s26, 0
    v_cmp_eq_u32 vcc, 20, v10
    v_mov_b32 v13, 0x3f803f80
    s_nop 0
    v_cndmask_b32 v13, 0, v13, vcc
    v_mov_b32 v40, v13
    v_mov_b32 v41, v13
    v_mov_b32 v42, v13
    v_mov_b32 v43, v13
    v_mov_b32 v44, v13
    v_mov_b32 v45, v13
    v_mov_b32 v46, v13
    v_mov_b32 v47, v13
    v_mov_b32 v56, v13
    v_mov_b32 v57, v13
    v_mov_b32 v58, v13
    v_mov_b32 v59, v13
    v_mov_b32 v60, v13
    v_mov_b32 v61, v13
    v_mov_b32 v62, v13
    v_mov_b32 v63, v13
    v_mov_b32 v216, v13
    v_mov_b32 v217, v13
    v_mov_b32 v218, v13
    v_mov_b32 v219, v13
    v_mov_b32 v220, v13
    v_mov_b32 v221, v13
    v_mov_b32 v222, v13
    v_mov_b32 v223, v13
    v_mov_b32 v232, v13
    v_mov_b32 v233, v13
    v_mov_b32 v234, v13
    v_mov_b32 v235, v13
    v_mov_b32 v236, v13
    v_mov_b32 v237, v13
    v_mov_b32 v238, v13
    v_mov_b32 v239, v13
    v_mov_b32 v72, 0
    v_mov_b32 v73, 0
    v_mov_b32 v74, 0
    v_mov_b32 v75, 0
    v_mov_b32 v76, 0
    v_mov_b32 v77, 0
    v_mov_b32 v78, 0
    v_mov_b32 v79, 0
    v_mov_b32 v112, 0
    v_mov_b32 v113, 0
    v_mov_b32 v114, 0
    v_mov_b32 v115, 0
    v_mov_b32 v116, 0
    v_mov_b32 v117, 0
    v_mov_b32 v118, 0
    v_mov_b32 v119, 0
    v_mov_b32 v120, 0
    v_mov_b32 v121, 0
    v_mov_b32 v122, 0
    v_mov_b32 v123, 0
    v_mov_b32 v124, 0
    v_mov_b32 v125, 0
    v_mov_b32 v126, 0
    v_mov_b32 v127, 0
    v_mov_b32 v128, 0
    v_mov_b32 v129, 0
    v_mov_b32 v130, 0
    v_mov_b32 v131, 0
    v_mov_b32 v132, 0
    v_mov_b32 v133, 0
    v_mov_b32 v134, 0
    v_mov_b32 v135, 0
    v_mov_b32 v136, 0
    v_mov_b32 v137, 0
    v_mov_b32 v138, 0
    v_mov_b32 v139, 0
    v_mov_b32 v140, 0
    v_mov_b32 v141, 0
    v_mov_b32 v142, 0
    v_mov_b32 v143, 0
    s_lshl_b32 s17, s21, 3
    s_add_u32 s54, s54, s17
    s_lshl_b32 s55, s13, 2
    s_add_u32 s55, s55, s59
    s_mul_i32 s19, s55, 160
    s_bitcmp1_b32 s12, 1
    s_cselect_b32 s44, s40, s6
    s_cselect_b32 s45, s41, s7
    s_and_b32 s45, s45, 0xffff
    s_mov_b32 s46, 819200
    s_mov_b32 s47, 0x00020000
    s_and_b32 s17, s12, 1
    s_mul_i32 s17, s17, 320
    s_lshr_b32 s18, s12, 2
    s_mul_i32 s18, s18, 40
    s_add_u32 s17, s17, s18
    s_mul_i32 s52, s17, 1280
    s_mul_i32 s53, s12, 5120
    s_add_u32 s53, s53, 81920
    s_add_u32 s52, s52, s19
    s_waitcnt vmcnt(11)
    v_max_f32 v13, v144, v145
    v_max_f32 v15, v146, v147
    s_nop 0
    v_max_f32_dpp v13, v13, v13 row_ror:8 row_mask:0xf bank_mask:0xf
    v_max_f32_dpp v15, v15, v15 row_ror:8 row_mask:0xf bank_mask:0xf
    s_nop 0
    v_max_f32_dpp v13, v13, v13 row_ror:4 row_mask:0xf bank_mask:0xf
    v_max_f32_dpp v15, v15, v15 row_ror:4 row_mask:0xf bank_mask:0xf
    s_nop 0
    v_max_f32_dpp v13, v13, v13 row_ror:2 row_mask:0xf bank_mask:0xf
    v_max_f32_dpp v15, v15, v15 row_ror:2 row_mask:0xf bank_mask:0xf
    s_nop 0
    v_max_f32_dpp v13, v13, v13 row_ror:1 row_mask:0xf bank_mask:0xf
    v_max_f32_dpp v15, v15, v15 row_ror:1 row_mask:0xf bank_mask:0xf
    v_mov_b32 v14, v13
    v_mov_b32 v144, v15
    s_nop 1
    v_permlane16_swap_b32 v13, v14
    v_permlane16_swap_b32 v15, v144
    v_max_f32 v13, v13, v14
    v_max_f32 v15, v15, v144
    v_mov_b32 v14, v13
    v_mov_b32 v144, v15
    s_nop 1
    v_permlane32_swap_b32 v13, v14
    v_permlane32_swap_b32 v15, v144
    v_max_f32 v13, v13, v14
    v_max_f32 v15, v15, v144
    v_add_f32 v13, v13, v15
    s_waitcnt vmcnt(5)
    v_dot2_f32_bf16 v6, v16, v16, 0
    v_dot2_f32_bf16 v7, v24, v24, 0
    v_dot2_f32_bf16 v6, v17, v17, v6
    v_dot2_f32_bf16 v7, v25, v25, v7
    v_dot2_f32_bf16 v6, v18, v18, v6
    v_dot2_f32_bf16 v7, v26, v26, v7
    v_dot2_f32_bf16 v6, v19, v19, v6
    v_dot2_f32_bf16 v7, v27, v27, v7
    v_dot2_f32_bf16 v6, v20, v20, v6
    v_dot2_f32_bf16 v7, v28, v28, v7
    v_dot2_f32_bf16 v6, v21, v21, v6
    v_dot2_f32_bf16 v7, v29, v29, v7
    s_nop 2
    v_mov_b32 v144, v6
    v_mov_b32 v145, v7
    s_nop 1
    v_permlane32_swap_b32 v144, v6
    v_permlane32_swap_b32 v145, v7
    v_add_f32 v6, v6, v144
    v_add_f32 v7, v7, v145
    v_mul_f32 v6, v6, v13
    v_mul_f32 v7, v7, v13
    v_sqrt_f32 v6, v6
    v_sqrt_f32 v7, v7
    s_nop 0
    v_sub_f32 v80, 0, v6
    v_sub_f32 v81, 0, v6
    v_sub_f32 v82, 0, v6
    v_sub_f32 v83, 0, v6
    v_sub_f32 v84, 0, v6
    v_sub_f32 v85, 0, v6
    v_sub_f32 v86, 0, v6
    v_sub_f32 v87, 0, v6
    v_sub_f32 v88, 0, v6
    v_sub_f32 v89, 0, v6
    v_sub_f32 v90, 0, v6
    v_sub_f32 v91, 0, v6
    v_sub_f32 v92, 0, v6
    v_sub_f32 v93, 0, v6
    v_sub_f32 v94, 0, v6
    v_sub_f32 v95, 0, v6
    v_sub_f32 v96, 0, v7
    v_sub_f32 v97, 0, v7
    v_sub_f32 v98, 0, v7
    v_sub_f32 v99, 0, v7
    v_sub_f32 v100, 0, v7
    v_sub_f32 v101, 0, v7
    v_sub_f32 v102, 0, v7
    v_sub_f32 v103, 0, v7
    v_sub_f32 v104, 0, v7
    v_sub_f32 v105, 0, v7
    v_sub_f32 v106, 0, v7
    v_sub_f32 v107, 0, v7
    v_sub_f32 v108, 0, v7
    v_sub_f32 v109, 0, v7
    v_sub_f32 v110, 0, v7
    v_sub_f32 v111, 0, v7
    v_mfma_f32_32x32x16_bf16 v[144:159], v[224:227], v[16:19], v[80:95]
    v_mfma_f32_32x32x8_bf16 v[144:159], v[228:229], v[20:21], v[144:159]
    s_waitcnt vmcnt(0)
    s_barrier
    ds_read_b128 v[32:35], v2 offset:0
    ds_read_b64 v[36:37], v3 offset:0
    ds_read_b128 v[48:51], v2 offset:2560
    ds_read_b64 v[52:53], v3 offset:2560
    s_mov_b64 exec, s[22:23]
    ds_read_b128 v[40:43], v4 offset:0
    ds_read_b128 v[44:47], v4 offset:640
    ds_read_b128 v[56:59], v4 offset:2560
    ds_read_b128 v[60:63], v4 offset:3200
    s_mov_b64 exec, -1
    s_lshl_b32 s17, s13, 13
    s_add_u32 s17, s17, s58
    s_add_u32 s17, s17, 11599872
    buffer_load_dword v8, v12, s[8:11], s17 offen
    buffer_load_dword v9, v12, s[8:11], s17 offen offset:128
    s_add_u32 m0, s27, 0
    s_mov_b32 s17, s28
    buffer_load_dwordx4 v5, s[8:11], s17 offen lds
    s_add_u32 m0, s27, 1024
    s_add_u32 s17, s28, 1024
    buffer_load_dwordx4 v5, s[8:11], s17 offen lds
    s_add_u32 m0, s27, 2048
    s_add_u32 s17, s28, 2048
    buffer_load_dwordx4 v5, s[8:11], s17 offen lds
    s_add_u32 m0, s27, 3072
    s_add_u32 s17, s28, 3072
    buffer_load_dwordx4 v5, s[8:11], s17 offen lds
    s_add_u32 m0, s27, 4096
    s_add_u32 s17, s28, 4096
    buffer_load_dwordx4 v5, s[8:11], s17 offen lds
    s_add_u32 s28, s28, 40960
    s_xor_b32 s27, s27, s33
    s_getpc_b64 s[60:61]
L_k2_pc:
    s_add_u32 s60, s60, L_wtab-L_k2_pc
    s_addc_u32 s61, s61, 0
    s_and_b32 s61, s61, 0xffff
    s_mov_b32 s62, 3072
    s_mov_b32 s63, 0x00020000
    buffer_load_dwordx4 v[192:195], v5, s[60:63], 0 offen
    buffer_load_dwordx4 v[196:199], v5, s[60:63], 0 offen offset:1024
    buffer_load_dwordx2 v[200:201], v5, s[60:63], 0 offen offset:2048
    s_nop 7
.p2align 6
L_k2_stage:
    v_mfma_f32_32x32x16_bf16 v[160:175], v[224:227], v[24:27], v[96:111]
    v_exp_f32 v144, v144
    v_exp_f32 v145, v145
    v_exp_f32 v146, v146
    v_exp_f32 v147, v147
    v_cvt_pk_bf16_f32 v64, v144, v145
    v_cvt_pk_bf16_f32 v65, v146, v147
    v_mfma_f32_32x32x8_bf16 v[160:175], v[228:229], v[28:29], v[160:175]
    v_exp_f32 v148, v148
    v_exp_f32 v149, v149
    v_exp_f32 v150, v150
    v_exp_f32 v151, v151
    v_cvt_pk_bf16_f32 v66, v148, v149
    v_cvt_pk_bf16_f32 v67, v150, v151
    v_mfma_f32_32x32x16_bf16 v[128:143], v[232:235], v[72:75], v[128:143]
    v_exp_f32 v152, v152
    v_exp_f32 v153, v153
    v_exp_f32 v154, v154
    v_exp_f32 v155, v155
    v_cvt_pk_bf16_f32 v68, v152, v153
    v_cvt_pk_bf16_f32 v69, v154, v155
    v_mfma_f32_32x32x16_bf16 v[128:143], v[236:239], v[76:79], v[128:143]
    v_exp_f32 v156, v156
    v_exp_f32 v157, v157
    v_exp_f32 v158, v158
    v_exp_f32 v159, v159
    v_cvt_pk_bf16_f32 v70, v156, v157
    v_cvt_pk_bf16_f32 v71, v158, v159
    s_waitcnt lgkmcnt(0)
    v_mfma_f32_32x32x16_bf16 v[144:159], v[32:35], v[16:19], v[80:95]
    ds_read_b128 v[208:211], v2 offset:5120
    ds_read_b64 v[212:213], v3 offset:5120
    ds_read_b128 v[224:227], v2 offset:7680
    ds_read_b64 v[228:229], v3 offset:7680
    v_exp_f32 v160, v160
    v_exp_f32 v161, v161
    v_exp_f32 v162, v162
    v_exp_f32 v163, v163
    v_cvt_pk_bf16_f32 v72, v160, v161
    v_cvt_pk_bf16_f32 v73, v162, v163
    v_mfma_f32_32x32x8_bf16 v[144:159], v[36:37], v[20:21], v[144:159]
    s_mov_b64 exec, s[22:23]
    ds_read_b128 v[216:219], v4 offset:5120
    ds_read_b128 v[220:223], v4 offset:5760
    ds_read_b128 v[232:235], v4 offset:7680
    ds_read_b128 v[236:239], v4 offset:8320
    s_mov_b64 exec, -1
    v_exp_f32 v164, v164
    v_exp_f32 v165, v165
    v_exp_f32 v166, v166
    v_exp_f32 v167, v167
    v_cvt_pk_bf16_f32 v74, v164, v165
    v_cvt_pk_bf16_f32 v75, v166, v167
    v_mfma_f32_32x32x16_bf16 v[112:127], v[40:43], v[64:67], v[112:127]
    v_exp_f32 v168, v168
    v_exp_f32 v169, v169
    v_exp_f32 v170, v170
    v_exp_f32 v171, v171
    v_cvt_pk_bf16_f32 v76, v168, v169
    v_cvt_pk_bf16_f32 v77, v170, v171
    v_mfma_f32_32x32x16_bf16 v[112:127], v[44:47], v[68:71], v[112:127]
    v_exp_f32 v172, v172
    v_exp_f32 v173, v173
    v_exp_f32 v174, v174
    v_exp_f32 v175, v175
    v_cvt_pk_bf16_f32 v78, v172, v173
    v_cvt_pk_bf16_f32 v79, v174, v175
    v_mfma_f32_32x32x16_bf16 v[160:175], v[32:35], v[24:27], v[96:111]
    v_exp_f32 v144, v144
    v_exp_f32 v145, v145
    v_exp_f32 v146, v146
    v_exp_f32 v147, v147
    v_cvt_pk_bf16_f32 v64, v144, v145
    v_cvt_pk_bf16_f32 v65, v146, v147
    v_mfma_f32_32x32x8_bf16 v[160:175], v[36:37], v[28:29], v[160:175]
    v_exp_f32 v148, v148
    v_exp_f32 v149, v149
    v_exp_f32 v150, v150
    v_exp_f32 v151, v151
    v_cvt_pk_bf16_f32 v66, v148, v149
    v_cvt_pk_bf16_f32 v67, v150, v151
    v_mfma_f32_32x32x16_bf16 v[128:143], v[40:43], v[72:75], v[128:143]
    v_exp_f32 v152, v152
    v_exp_f32 v153, v153
    v_exp_f32 v154, v154
    v_exp_f32 v155, v155
    v_cvt_pk_bf16_f32 v68, v152, v153
    v_cvt_pk_bf16_f32 v69, v154, v155
    v_mfma_f32_32x32x16_bf16 v[128:143], v[44:47], v[76:79], v[128:143]
    v_exp_f32 v156, v156
    v_exp_f32 v157, v157
    v_exp_f32 v158, v158
    v_exp_f32 v159, v159
    v_cvt_pk_bf16_f32 v70, v156, v157
    v_cvt_pk_bf16_f32 v71, v158, v159
    v_mfma_f32_32x32x16_bf16 v[144:159], v[48:51], v[16:19], v[80:95]
    v_exp_f32 v160, v160
    v_exp_f32 v161, v161
    v_exp_f32 v162, v162
    v_exp_f32 v163, v163
    v_cvt_pk_bf16_f32 v72, v160, v161
    v_cvt_pk_bf16_f32 v73, v162, v163
    v_mfma_f32_32x32x8_bf16 v[144:159], v[52:53], v[20:21], v[144:159]
    v_exp_f32 v164, v164
    v_exp_f32 v165, v165
    v_exp_f32 v166, v166
    v_exp_f32 v167, v167
    v_cvt_pk_bf16_f32 v74, v164, v165
    v_cvt_pk_bf16_f32 v75, v166, v167
    v_mfma_f32_32x32x16_bf16 v[112:127], v[56:59], v[64:67], v[112:127]
    v_exp_f32 v168, v168
    v_exp_f32 v169, v169
    v_exp_f32 v170, v170
    v_exp_f32 v171, v171
    v_cvt_pk_bf16_f32 v76, v168, v169
    v_cvt_pk_bf16_f32 v77, v170, v171
    v_mfma_f32_32x32x16_bf16 v[112:127], v[60:63], v[68:71], v[112:127]
    v_exp_f32 v172, v172
    v_exp_f32 v173, v173
    v_exp_f32 v174, v174
    v_exp_f32 v175, v175
    v_cvt_pk_bf16_f32 v78, v172, v173
    v_cvt_pk_bf16_f32 v79, v174, v175
    v_mfma_f32_32x32x16_bf16 v[160:175], v[48:51], v[24:27], v[96:111]
    v_exp_f32 v144, v144
    v_exp_f32 v145, v145
    v_exp_f32 v146, v146
    v_exp_f32 v147, v147
    v_cvt_pk_bf16_f32 v64, v144, v145
    v_cvt_pk_bf16_f32 v65, v146, v147
    v_mfma_f32_32x32x8_bf16 v[160:175], v[52:53], v[28:29], v[160:175]
    v_exp_f32 v148, v148
    v_exp_f32 v149, v149
    v_exp_f32 v150, v150
    v_exp_f32 v151, v151
    v_cvt_pk_bf16_f32 v66, v148, v149
    v_cvt_pk_bf16_f32 v67, v150, v151
    v_mfma_f32_32x32x16_bf16 v[128:143], v[56:59], v[72:75], v[128:143]
    v_exp_f32 v152, v152
    v_exp_f32 v153, v153
    v_exp_f32 v154, v154
    v_exp_f32 v155, v155
    v_cvt_pk_bf16_f32 v68, v152, v153
    v_cvt_pk_bf16_f32 v69, v154, v155
    v_mfma_f32_32x32x16_bf16 v[128:143], v[60:63], v[76:79], v[128:143]
    v_exp_f32 v156, v156
    v_exp_f32 v157, v157
    v_exp_f32 v158, v158
    v_exp_f32 v159, v159
    v_cvt_pk_bf16_f32 v70, v156, v157
    v_cvt_pk_bf16_f32 v71, v158, v159
    s_waitcnt lgkmcnt(0)
    v_mfma_f32_32x32x16_bf16 v[144:159], v[208:211], v[16:19], v[80:95]
    ds_read_b128 v[32:35], v2 offset:10240
    ds_read_b64 v[36:37], v3 offset:10240
    ds_read_b128 v[48:51], v2 offset:12800
    ds_read_b64 v[52:53], v3 offset:12800
    v_exp_f32 v160, v160
    v_exp_f32 v161, v161
    v_exp_f32 v162, v162
    v_exp_f32 v163, v163
    v_cvt_pk_bf16_f32 v72, v160, v161
    v_cvt_pk_bf16_f32 v73, v162, v163
    v_mfma_f32_32x32x8_bf16 v[144:159], v[212:213], v[20:21], v[144:159]
    s_mov_b64 exec, s[22:23]
    ds_read_b128 v[40:43], v4 offset:10240
    ds_read_b128 v[44:47], v4 offset:10880
    ds_read_b128 v[56:59], v4 offset:12800
    ds_read_b128 v[60:63], v4 offset:13440
    s_mov_b64 exec, -1
    v_exp_f32 v164, v164
    v_exp_f32 v165, v165
    v_exp_f32 v166, v166
    v_exp_f32 v167, v167
    v_cvt_pk_bf16_f32 v74, v164, v165
    v_cvt_pk_bf16_f32 v75, v166, v167
    v_mfma_f32_32x32x16_bf16 v[112:127], v[216:219], v[64:67], v[112:127]
    v_exp_f32 v168, v168
    v_exp_f32 v169, v169
    v_exp_f32 v170, v170
    v_exp_f32 v171, v171
    v_cvt_pk_bf16_f32 v76, v168, v169
    v_cvt_pk_bf16_f32 v77, v170, v171
    v_mfma_f32_32x32x16_bf16 v[112:127], v[220:223], v[68:71], v[112:127]
    v_exp_f32 v172, v172
    v_exp_f32 v173, v173
    v_exp_f32 v174, v174
    v_exp_f32 v175, v175
    v_cvt_pk_bf16_f32 v78, v172, v173
    v_cvt_pk_bf16_f32 v79, v174, v175
    v_mfma_f32_32x32x16_bf16 v[160:175], v[208:211], v[24:27], v[96:111]
    v_exp_f32 v144, v144
    v_exp_f32 v145, v145
    v_exp_f32 v146, v146
    v_exp_f32 v147, v147
    v_cvt_pk_bf16_f32 v64, v144, v145
    v_cvt_pk_bf16_f32 v65, v146, v147
    v_mfma_f32_32x32x8_bf16 v[160:175], v[212:213], v[28:29], v[160:175]
    v_exp_f32 v148, v148
    v_exp_f32 v149, v149
    v_exp_f32 v150, v150
    v_exp_f32 v151, v151
    v_cvt_pk_bf16_f32 v66, v148, v149
    v_cvt_pk_bf16_f32 v67, v150, v151
    v_mfma_f32_32x32x16_bf16 v[128:143], v[216:219], v[72:75], v[128:143]
    v_exp_f32 v152, v152
    v_exp_f32 v153, v153
    v_exp_f32 v154, v154
    v_exp_f32 v155, v155
    v_cvt_pk_bf16_f32 v68, v152, v153
    v_cvt_pk_bf16_f32 v69, v154, v155
    v_mfma_f32_32x32x16_bf16 v[128:143], v[220:223], v[76:79], v[128:143]
    v_exp_f32 v156, v156
    v_exp_f32 v157, v157
    v_exp_f32 v158, v158
    v_exp_f32 v159, v159
    v_cvt_pk_bf16_f32 v70, v156, v157
    v_cvt_pk_bf16_f32 v71, v158, v159
    v_mfma_f32_32x32x16_bf16 v[144:159], v[224:227], v[16:19], v[80:95]
    v_exp_f32 v160, v160
    v_exp_f32 v161, v161
    v_exp_f32 v162, v162
    v_exp_f32 v163, v163
    v_cvt_pk_bf16_f32 v72, v160, v161
    v_cvt_pk_bf16_f32 v73, v162, v163
    v_mfma_f32_32x32x8_bf16 v[144:159], v[228:229], v[20:21], v[144:159]
    v_exp_f32 v164, v164
    v_exp_f32 v165, v165
    v_exp_f32 v166, v166
    v_exp_f32 v167, v167
    v_cvt_pk_bf16_f32 v74, v164, v165
    v_cvt_pk_bf16_f32 v75, v166, v167
    v_mfma_f32_32x32x16_bf16 v[112:127], v[232:235], v[64:67], v[112:127]
    v_exp_f32 v168, v168
    v_exp_f32 v169, v169
    v_exp_f32 v170, v170
    v_exp_f32 v171, v171
    v_cvt_pk_bf16_f32 v76, v168, v169
    v_cvt_pk_bf16_f32 v77, v170, v171
    v_mfma_f32_32x32x16_bf16 v[112:127], v[236:239], v[68:71], v[112:127]
    v_exp_f32 v172, v172
    v_exp_f32 v173, v173
    v_exp_f32 v174, v174
    v_exp_f32 v175, v175
    v_cvt_pk_bf16_f32 v78, v172, v173
    v_cvt_pk_bf16_f32 v79, v174, v175
    v_mfma_f32_32x32x16_bf16 v[160:175], v[224:227], v[24:27], v[96:111]
    v_exp_f32 v144, v144
    v_exp_f32 v145, v145
    v_exp_f32 v146, v146
    v_exp_f32 v147, v147
    v_cvt_pk_bf16_f32 v64, v144, v145
    v_cvt_pk_bf16_f32 v65, v146, v147
    v_mfma_f32_32x32x8_bf16 v[160:175], v[228:229], v[28:29], v[160:175]
    v_exp_f32 v148, v148
    v_exp_f32 v149, v149
    v_exp_f32 v150, v150
    v_exp_f32 v151, v151
    v_cvt_pk_bf16_f32 v66, v148, v149
    v_cvt_pk_bf16_f32 v67, v150, v151
    v_mfma_f32_32x32x16_bf16 v[128:143], v[232:235], v[72:75], v[128:143]
    v_exp_f32 v152, v152
    v_exp_f32 v153, v153
    v_exp_f32 v154, v154
    v_exp_f32 v155, v155
    v_cvt_pk_bf16_f32 v68, v152, v153
    v_cvt_pk_bf16_f32 v69, v154, v155
    v_mfma_f32_32x32x16_bf16 v[128:143], v[236:239], v[76:79], v[128:143]
    v_exp_f32 v156, v156
    v_exp_f32 v157, v157
    v_exp_f32 v158, v158
    v_exp_f32 v159, v159
    v_cvt_pk_bf16_f32 v70, v156, v157
    v_cvt_pk_bf16_f32 v71, v158, v159
    s_waitcnt lgkmcnt(0)
    v_mfma_f32_32x32x16_bf16 v[144:159], v[32:35], v[16:19], v[80:95]
    ds_read_b128 v[208:211], v2 offset:15360
    ds_read_b64 v[212:213], v3 offset:15360
    ds_read_b128 v[224:227], v2 offset:17920
    ds_read_b64 v[228:229], v3 offset:17920
    v_exp_f32 v160, v160
    v_exp_f32 v161, v161
    v_exp_f32 v162, v162
    v_exp_f32 v163, v163
    v_cvt_pk_bf16_f32 v72, v160, v161
    v_cvt_pk_bf16_f32 v73, v162, v163
    v_mfma_f32_32x32x8_bf16 v[144:159], v[36:37], v[20:21], v[144:159]
    s_mov_b64 exec, s[22:23]
    ds_read_b128 v[216:219], v4 offset:15360
    ds_read_b128 v[220:223], v4 offset:16000
    ds_read_b128 v[232:235], v4 offset:17920
    ds_read_b128 v[236:239], v4 offset:18560
    s_mov_b64 exec, -1
    v_exp_f32 v164, v164
    v_exp_f32 v165, v165
    v_exp_f32 v166, v166
    v_exp_f32 v167, v167
    v_cvt_pk_bf16_f32 v74, v164, v165
    v_cvt_pk_bf16_f32 v75, v166, v167
    v_mfma_f32_32x32x16_bf16 v[112:127], v[40:43], v[64:67], v[112:127]
    v_exp_f32 v168, v168
    v_exp_f32 v169, v169
    v_exp_f32 v170, v170
    v_exp_f32 v171, v171
    v_cvt_pk_bf16_f32 v76, v168, v169
    v_cvt_pk_bf16_f32 v77, v170, v171
    v_mfma_f32_32x32x16_bf16 v[112:127], v[44:47], v[68:71], v[112:127]
    v_exp_f32 v172, v172
    v_exp_f32 v173, v173
    v_exp_f32 v174, v174
    v_exp_f32 v175, v175
    v_cvt_pk_bf16_f32 v78, v172, v173
    v_cvt_pk_bf16_f32 v79, v174, v175
    v_mfma_f32_32x32x16_bf16 v[160:175], v[32:35], v[24:27], v[96:111]
    v_exp_f32 v144, v144
    v_exp_f32 v145, v145
    v_exp_f32 v146, v146
    v_exp_f32 v147, v147
    v_cvt_pk_bf16_f32 v64, v144, v145
    v_cvt_pk_bf16_f32 v65, v146, v147
    v_mfma_f32_32x32x8_bf16 v[160:175], v[36:37], v[28:29], v[160:175]
    v_exp_f32 v148, v148
    v_exp_f32 v149, v149
    v_exp_f32 v150, v150
    v_exp_f32 v151, v151
    v_cvt_pk_bf16_f32 v66, v148, v149
    v_cvt_pk_bf16_f32 v67, v150, v151
    v_mfma_f32_32x32x16_bf16 v[128:143], v[40:43], v[72:75], v[128:143]
    v_exp_f32 v152, v152
    v_exp_f32 v153, v153
    v_exp_f32 v154, v154
    v_exp_f32 v155, v155
    v_cvt_pk_bf16_f32 v68, v152, v153
    v_cvt_pk_bf16_f32 v69, v154, v155
    v_mfma_f32_32x32x16_bf16 v[128:143], v[44:47], v[76:79], v[128:143]
    v_exp_f32 v156, v156
    v_exp_f32 v157, v157
    v_exp_f32 v158, v158
    v_exp_f32 v159, v159
    v_cvt_pk_bf16_f32 v70, v156, v157
    v_cvt_pk_bf16_f32 v71, v158, v159
    v_mfma_f32_32x32x16_bf16 v[144:159], v[48:51], v[16:19], v[80:95]
    v_exp_f32 v160, v160
    v_exp_f32 v161, v161
    v_exp_f32 v162, v162
    v_exp_f32 v163, v163
    v_cvt_pk_bf16_f32 v72, v160, v161
    v_cvt_pk_bf16_f32 v73, v162, v163
    v_mfma_f32_32x32x8_bf16 v[144:159], v[52:53], v[20:21], v[144:159]
    v_exp_f32 v164, v164
    v_exp_f32 v165, v165
    v_exp_f32 v166, v166
    v_exp_f32 v167, v167
    v_cvt_pk_bf16_f32 v74, v164, v165
    v_cvt_pk_bf16_f32 v75, v166, v167
    v_mfma_f32_32x32x16_bf16 v[112:127], v[56:59], v[64:67], v[112:127]
    v_exp_f32 v168, v168
    v_exp_f32 v169, v169
    v_exp_f32 v170, v170
    v_exp_f32 v171, v171
    v_cvt_pk_bf16_f32 v76, v168, v169
    v_cvt_pk_bf16_f32 v77, v170, v171
    v_mfma_f32_32x32x16_bf16 v[112:127], v[60:63], v[68:71], v[112:127]
    v_exp_f32 v172, v172
    v_exp_f32 v173, v173
    v_exp_f32 v174, v174
    v_exp_f32 v175, v175
    v_cvt_pk_bf16_f32 v78, v172, v173
    v_cvt_pk_bf16_f32 v79, v174, v175
    v_mfma_f32_32x32x16_bf16 v[160:175], v[48:51], v[24:27], v[96:111]
    v_exp_f32 v144, v144
    v_exp_f32 v145, v145
    v_exp_f32 v146, v146
    v_exp_f32 v147, v147
    v_cvt_pk_bf16_f32 v64, v144, v145
    v_cvt_pk_bf16_f32 v65, v146, v147
    v_mfma_f32_32x32x8_bf16 v[160:175], v[52:53], v[28:29], v[160:175]
    v_exp_f32 v148, v148
    v_exp_f32 v149, v149
    v_exp_f32 v150, v150
    v_exp_f32 v151, v151
    v_cvt_pk_bf16_f32 v66, v148, v149
    v_cvt_pk_bf16_f32 v67, v150, v151
    v_mfma_f32_32x32x16_bf16 v[128:143], v[56:59], v[72:75], v[128:143]
    v_exp_f32 v152, v152
    v_exp_f32 v153, v153
    v_exp_f32 v154, v154
    v_exp_f32 v155, v155
    v_cvt_pk_bf16_f32 v68, v152, v153
    v_cvt_pk_bf16_f32 v69, v154, v155
    v_mfma_f32_32x32x16_bf16 v[128:143], v[60:63], v[76:79], v[128:143]
    v_exp_f32 v156, v156
    v_exp_f32 v157, v157
    v_exp_f32 v158, v158
    v_exp_f32 v159, v159
    v_cvt_pk_bf16_f32 v70, v156, v157
    v_cvt_pk_bf16_f32 v71, v158, v159
    s_waitcnt lgkmcnt(0)
    v_mfma_f32_32x32x16_bf16 v[144:159], v[208:211], v[16:19], v[80:95]
    ds_read_b128 v[32:35], v2 offset:20480
    ds_read_b64 v[36:37], v3 offset:20480
    ds_read_b128 v[48:51], v2 offset:23040
    ds_read_b64 v[52:53], v3 offset:23040
    v_exp_f32 v160, v160
    v_exp_f32 v161, v161
    v_exp_f32 v162, v162
    v_exp_f32 v163, v163
    v_cvt_pk_bf16_f32 v72, v160, v161
    v_cvt_pk_bf16_f32 v73, v162, v163
    v_mfma_f32_32x32x8_bf16 v[144:159], v[212:213], v[20:21], v[144:159]
    s_mov_b64 exec, s[22:23]
    ds_read_b128 v[40:43], v4 offset:20480
    ds_read_b128 v[44:47], v4 offset:21120
    ds_read_b128 v[56:59], v4 offset:23040
    ds_read_b128 v[60:63], v4 offset:23680
    s_mov_b64 exec, -1
    v_exp_f32 v164, v164
    v_exp_f32 v165, v165
    v_exp_f32 v166, v166
    v_exp_f32 v167, v167
    v_cvt_pk_bf16_f32 v74, v164, v165
    v_cvt_pk_bf16_f32 v75, v166, v167
    v_mfma_f32_32x32x16_bf16 v[112:127], v[216:219], v[64:67], v[112:127]
    v_exp_f32 v168, v168
    v_exp_f32 v169, v169
    v_exp_f32 v170, v170
    v_exp_f32 v171, v171
    v_cvt_pk_bf16_f32 v76, v168, v169
    v_cvt_pk_bf16_f32 v77, v170, v171
    v_mfma_f32_32x32x16_bf16 v[112:127], v[220:223], v[68:71], v[112:127]
    v_exp_f32 v172, v172
    v_exp_f32 v173, v173
    v_exp_f32 v174, v174
    v_exp_f32 v175, v175
    v_cvt_pk_bf16_f32 v78, v172, v173
    v_cvt_pk_bf16_f32 v79, v174, v175
    v_mfma_f32_32x32x16_bf16 v[160:175], v[208:211], v[24:27], v[96:111]
    v_exp_f32 v144, v144
    v_exp_f32 v145, v145
    v_exp_f32 v146, v146
    v_exp_f32 v147, v147
    v_cvt_pk_bf16_f32 v64, v144, v145
    v_cvt_pk_bf16_f32 v65, v146, v147
    v_mfma_f32_32x32x8_bf16 v[160:175], v[212:213], v[28:29], v[160:175]
    v_exp_f32 v148, v148
    v_exp_f32 v149, v149
    v_exp_f32 v150, v150
    v_exp_f32 v151, v151
    v_cvt_pk_bf16_f32 v66, v148, v149
    v_cvt_pk_bf16_f32 v67, v150, v151
    v_mfma_f32_32x32x16_bf16 v[128:143], v[216:219], v[72:75], v[128:143]
    v_exp_f32 v152, v152
    v_exp_f32 v153, v153
    v_exp_f32 v154, v154
    v_exp_f32 v155, v155
    v_cvt_pk_bf16_f32 v68, v152, v153
    v_cvt_pk_bf16_f32 v69, v154, v155
    v_mfma_f32_32x32x16_bf16 v[128:143], v[220:223], v[76:79], v[128:143]
    v_exp_f32 v156, v156
    v_exp_f32 v157, v157
    v_exp_f32 v158, v158
    v_exp_f32 v159, v159
    v_cvt_pk_bf16_f32 v70, v156, v157
    v_cvt_pk_bf16_f32 v71, v158, v159
    v_mfma_f32_32x32x16_bf16 v[144:159], v[224:227], v[16:19], v[80:95]
    v_exp_f32 v160, v160
    v_exp_f32 v161, v161
    v_exp_f32 v162, v162
    v_exp_f32 v163, v163
    v_cvt_pk_bf16_f32 v72, v160, v161
    v_cvt_pk_bf16_f32 v73, v162, v163
    v_mfma_f32_32x32x8_bf16 v[144:159], v[228:229], v[20:21], v[144:159]
    v_exp_f32 v164, v164
    v_exp_f32 v165, v165
    v_exp_f32 v166, v166
    v_exp_f32 v167, v167
    v_cvt_pk_bf16_f32 v74, v164, v165
    v_cvt_pk_bf16_f32 v75, v166, v167
    v_mfma_f32_32x32x16_bf16 v[112:127], v[232:235], v[64:67], v[112:127]
    v_exp_f32 v168, v168
    v_exp_f32 v169, v169
    v_exp_f32 v170, v170
    v_exp_f32 v171, v171
    v_cvt_pk_bf16_f32 v76, v168, v169
    v_cvt_pk_bf16_f32 v77, v170, v171
    v_mfma_f32_32x32x16_bf16 v[112:127], v[236:239], v[68:71], v[112:127]
    v_exp_f32 v172, v172
    v_exp_f32 v173, v173
    v_exp_f32 v174, v174
    v_exp_f32 v175, v175
    v_cvt_pk_bf16_f32 v78, v172, v173
    v_cvt_pk_bf16_f32 v79, v174, v175
    v_mfma_f32_32x32x16_bf16 v[160:175], v[224:227], v[24:27], v[96:111]
    v_exp_f32 v144, v144
    v_exp_f32 v145, v145
    v_exp_f32 v146, v146
    v_exp_f32 v147, v147
    v_cvt_pk_bf16_f32 v64, v144, v145
    v_cvt_pk_bf16_f32 v65, v146, v147
    v_mfma_f32_32x32x8_bf16 v[160:175], v[228:229], v[28:29], v[160:175]
    v_exp_f32 v148, v148
    v_exp_f32 v149, v149
    v_exp_f32 v150, v150
    v_exp_f32 v151, v151
    v_cvt_pk_bf16_f32 v66, v148, v149
    v_cvt_pk_bf16_f32 v67, v150, v151
    v_mfma_f32_32x32x16_bf16 v[128:143], v[232:235], v[72:75], v[128:143]
    v_exp_f32 v152, v152
    v_exp_f32 v153, v153
    v_exp_f32 v154, v154
    v_exp_f32 v155, v155
    v_cvt_pk_bf16_f32 v68, v152, v153
    v_cvt_pk_bf16_f32 v69, v154, v155
    v_mfma_f32_32x32x16_bf16 v[128:143], v[236:239], v[76:79], v[128:143]
    v_exp_f32 v156, v156
    v_exp_f32 v157, v157
    v_exp_f32 v158, v158
    v_exp_f32 v159, v159
    v_cvt_pk_bf16_f32 v70, v156, v157
    v_cvt_pk_bf16_f32 v71, v158, v159
    s_waitcnt lgkmcnt(0)
    v_mfma_f32_32x32x16_bf16 v[144:159], v[32:35], v[16:19], v[80:95]
    ds_read_b128 v[208:211], v2 offset:25600
    ds_read_b64 v[212:213], v3 offset:25600
    ds_read_b128 v[224:227], v2 offset:28160
    ds_read_b64 v[228:229], v3 offset:28160
    v_exp_f32 v160, v160
    v_exp_f32 v161, v161
    v_exp_f32 v162, v162
    v_exp_f32 v163, v163
    v_cvt_pk_bf16_f32 v72, v160, v161
    v_cvt_pk_bf16_f32 v73, v162, v163
    v_mfma_f32_32x32x8_bf16 v[144:159], v[36:37], v[20:21], v[144:159]
    s_mov_b64 exec, s[22:23]
    ds_read_b128 v[216:219], v4 offset:25600
    ds_read_b128 v[220:223], v4 offset:26240
    ds_read_b128 v[232:235], v4 offset:28160
    ds_read_b128 v[236:239], v4 offset:28800
    s_mov_b64 exec, -1
    v_exp_f32 v164, v164
    v_exp_f32 v165, v165
    v_exp_f32 v166, v166
    v_exp_f32 v167, v167
    v_cvt_pk_bf16_f32 v74, v164, v165
    v_cvt_pk_bf16_f32 v75, v166, v167
    v_mfma_f32_32x32x16_bf16 v[112:127], v[40:43], v[64:67], v[112:127]
    v_exp_f32 v168, v168
    v_exp_f32 v169, v169
    v_exp_f32 v170, v170
    v_exp_f32 v171, v171
    v_cvt_pk_bf16_f32 v76, v168, v169
    v_cvt_pk_bf16_f32 v77, v170, v171
    v_mfma_f32_32x32x16_bf16 v[112:127], v[44:47], v[68:71], v[112:127]
    v_exp_f32 v172, v172
    v_exp_f32 v173, v173
    v_exp_f32 v174, v174
    v_exp_f32 v175, v175
    v_cvt_pk_bf16_f32 v78, v172, v173
    v_cvt_pk_bf16_f32 v79, v174, v175
    v_mfma_f32_32x32x16_bf16 v[160:175], v[32:35], v[24:27], v[96:111]
    v_exp_f32 v144, v144
    v_exp_f32 v145, v145
    v_exp_f32 v146, v146
    v_exp_f32 v147, v147
    v_cvt_pk_bf16_f32 v64, v144, v145
    v_cvt_pk_bf16_f32 v65, v146, v147
    v_mfma_f32_32x32x8_bf16 v[160:175], v[36:37], v[28:29], v[160:175]
    v_exp_f32 v148, v148
    v_exp_f32 v149, v149
    v_exp_f32 v150, v150
    v_exp_f32 v151, v151
    v_cvt_pk_bf16_f32 v66, v148, v149
    v_cvt_pk_bf16_f32 v67, v150, v151
    v_mfma_f32_32x32x16_bf16 v[128:143], v[40:43], v[72:75], v[128:143]
    v_exp_f32 v152, v152
    v_exp_f32 v153, v153
    v_exp_f32 v154, v154
    v_exp_f32 v155, v155
    v_cvt_pk_bf16_f32 v68, v152, v153
    v_cvt_pk_bf16_f32 v69, v154, v155
    v_mfma_f32_32x32x16_bf16 v[128:143], v[44:47], v[76:79], v[128:143]
    v_exp_f32 v156, v156
    v_exp_f32 v157, v157
    v_exp_f32 v158, v158
    v_exp_f32 v159, v159
    v_cvt_pk_bf16_f32 v70, v156, v157
    v_cvt_pk_bf16_f32 v71, v158, v159
    v_mfma_f32_32x32x16_bf16 v[144:159], v[48:51], v[16:19], v[80:95]
    v_exp_f32 v160, v160
    v_exp_f32 v161, v161
    v_exp_f32 v162, v162
    v_exp_f32 v163, v163
    v_cvt_pk_bf16_f32 v72, v160, v161
    v_cvt_pk_bf16_f32 v73, v162, v163
    v_mfma_f32_32x32x8_bf16 v[144:159], v[52:53], v[20:21], v[144:159]
    v_exp_f32 v164, v164
    v_exp_f32 v165, v165
    v_exp_f32 v166, v166
    v_exp_f32 v167, v167
    v_cvt_pk_bf16_f32 v74, v164, v165
    v_cvt_pk_bf16_f32 v75, v166, v167
    v_mfma_f32_32x32x16_bf16 v[112:127], v[56:59], v[64:67], v[112:127]
    v_exp_f32 v168, v168
    v_exp_f32 v169, v169
    v_exp_f32 v170, v170
    v_exp_f32 v171, v171
    v_cvt_pk_bf16_f32 v76, v168, v169
    v_cvt_pk_bf16_f32 v77, v170, v171
    v_mfma_f32_32x32x16_bf16 v[112:127], v[60:63], v[68:71], v[112:127]
    v_exp_f32 v172, v172
    v_exp_f32 v173, v173
    v_exp_f32 v174, v174
    v_exp_f32 v175, v175
    v_cvt_pk_bf16_f32 v78, v172, v173
    v_cvt_pk_bf16_f32 v79, v174, v175
    v_mfma_f32_32x32x16_bf16 v[160:175], v[48:51], v[24:27], v[96:111]
    v_exp_f32 v144, v144
    v_exp_f32 v145, v145
    v_exp_f32 v146, v146
    v_exp_f32 v147, v147
    v_cvt_pk_bf16_f32 v64, v144, v145
    v_cvt_pk_bf16_f32 v65, v146, v147
    v_mfma_f32_32x32x8_bf16 v[160:175], v[52:53], v[28:29], v[160:175]
    v_exp_f32 v148, v148
    v_exp_f32 v149, v149
    v_exp_f32 v150, v150
    v_exp_f32 v151, v151
    v_cvt_pk_bf16_f32 v66, v148, v149
    v_cvt_pk_bf16_f32 v67, v150, v151
    v_mfma_f32_32x32x16_bf16 v[128:143], v[56:59], v[72:75], v[128:143]
    v_exp_f32 v152, v152
    v_exp_f32 v153, v153
    v_exp_f32 v154, v154
    v_exp_f32 v155, v155
    v_cvt_pk_bf16_f32 v68, v152, v153
    v_cvt_pk_bf16_f32 v69, v154, v155
    v_mfma_f32_32x32x16_bf16 v[128:143], v[60:63], v[76:79], v[128:143]
    v_exp_f32 v156, v156
    v_exp_f32 v157, v157
    v_exp_f32 v158, v158
    v_exp_f32 v159, v159
    v_cvt_pk_bf16_f32 v70, v156, v157
    v_cvt_pk_bf16_f32 v71, v158, v159
    s_waitcnt lgkmcnt(0)
    v_mfma_f32_32x32x16_bf16 v[144:159], v[208:211], v[16:19], v[80:95]
    ds_read_b128 v[32:35], v2 offset:30720
    ds_read_b64 v[36:37], v3 offset:30720
    ds_read_b128 v[48:51], v2 offset:33280
    ds_read_b64 v[52:53], v3 offset:33280
    v_exp_f32 v160, v160
    v_exp_f32 v161, v161
    v_exp_f32 v162, v162
    v_exp_f32 v163, v163
    v_cvt_pk_bf16_f32 v72, v160, v161
    v_cvt_pk_bf16_f32 v73, v162, v163
    v_mfma_f32_32x32x8_bf16 v[144:159], v[212:213], v[20:21], v[144:159]
    s_mov_b64 exec, s[22:23]
    ds_read_b128 v[40:43], v4 offset:30720
    ds_read_b128 v[44:47], v4 offset:31360
    ds_read_b128 v[56:59], v4 offset:33280
    ds_read_b128 v[60:63], v4 offset:33920
    s_mov_b64 exec, -1
    v_exp_f32 v164, v164
    v_exp_f32 v165, v165
    v_exp_f32 v166, v166
    v_exp_f32 v167, v167
    v_cvt_pk_bf16_f32 v74, v164, v165
    v_cvt_pk_bf16_f32 v75, v166, v167
    v_mfma_f32_32x32x16_bf16 v[112:127], v[216:219], v[64:67], v[112:127]
    v_exp_f32 v168, v168
    v_exp_f32 v169, v169
    v_exp_f32 v170, v170
    v_exp_f32 v171, v171
    v_cvt_pk_bf16_f32 v76, v168, v169
    v_cvt_pk_bf16_f32 v77, v170, v171
    v_mfma_f32_32x32x16_bf16 v[112:127], v[220:223], v[68:71], v[112:127]
    v_exp_f32 v172, v172
    v_exp_f32 v173, v173
    v_exp_f32 v174, v174
    v_exp_f32 v175, v175
    v_cvt_pk_bf16_f32 v78, v172, v173
    v_cvt_pk_bf16_f32 v79, v174, v175
    v_mfma_f32_32x32x16_bf16 v[160:175], v[208:211], v[24:27], v[96:111]
    v_exp_f32 v144, v144
    v_exp_f32 v145, v145
    v_exp_f32 v146, v146
    v_exp_f32 v147, v147
    v_cvt_pk_bf16_f32 v64, v144, v145
    v_cvt_pk_bf16_f32 v65, v146, v147
    v_mfma_f32_32x32x8_bf16 v[160:175], v[212:213], v[28:29], v[160:175]
    v_exp_f32 v148, v148
    v_exp_f32 v149, v149
    v_exp_f32 v150, v150
    v_exp_f32 v151, v151
    v_cvt_pk_bf16_f32 v66, v148, v149
    v_cvt_pk_bf16_f32 v67, v150, v151
    v_mfma_f32_32x32x16_bf16 v[128:143], v[216:219], v[72:75], v[128:143]
    v_exp_f32 v152, v152
    v_exp_f32 v153, v153
    v_exp_f32 v154, v154
    v_exp_f32 v155, v155
    v_cvt_pk_bf16_f32 v68, v152, v153
    v_cvt_pk_bf16_f32 v69, v154, v155
    v_mfma_f32_32x32x16_bf16 v[128:143], v[220:223], v[76:79], v[128:143]
    v_exp_f32 v156, v156
    v_exp_f32 v157, v157
    v_exp_f32 v158, v158
    v_exp_f32 v159, v159
    v_cvt_pk_bf16_f32 v70, v156, v157
    v_cvt_pk_bf16_f32 v71, v158, v159
    v_mfma_f32_32x32x16_bf16 v[144:159], v[224:227], v[16:19], v[80:95]
    v_exp_f32 v160, v160
    v_exp_f32 v161, v161
    v_exp_f32 v162, v162
    v_exp_f32 v163, v163
    v_cvt_pk_bf16_f32 v72, v160, v161
    v_cvt_pk_bf16_f32 v73, v162, v163
    v_mfma_f32_32x32x8_bf16 v[144:159], v[228:229], v[20:21], v[144:159]
    v_exp_f32 v164, v164
    v_exp_f32 v165, v165
    v_exp_f32 v166, v166
    v_exp_f32 v167, v167
    v_cvt_pk_bf16_f32 v74, v164, v165
    v_cvt_pk_bf16_f32 v75, v166, v167
    v_mfma_f32_32x32x16_bf16 v[112:127], v[232:235], v[64:67], v[112:127]
    v_exp_f32 v168, v168
    v_exp_f32 v169, v169
    v_exp_f32 v170, v170
    v_exp_f32 v171, v171
    v_cvt_pk_bf16_f32 v76, v168, v169
    v_cvt_pk_bf16_f32 v77, v170, v171
    v_mfma_f32_32x32x16_bf16 v[112:127], v[236:239], v[68:71], v[112:127]
    v_exp_f32 v172, v172
    v_exp_f32 v173, v173
    v_exp_f32 v174, v174
    v_exp_f32 v175, v175
    v_cvt_pk_bf16_f32 v78, v172, v173
    v_cvt_pk_bf16_f32 v79, v174, v175
    v_mfma_f32_32x32x16_bf16 v[160:175], v[224:227], v[24:27], v[96:111]
    v_exp_f32 v144, v144
    v_exp_f32 v145, v145
    v_exp_f32 v146, v146
    v_exp_f32 v147, v147
    v_cvt_pk_bf16_f32 v64, v144, v145
    v_cvt_pk_bf16_f32 v65, v146, v147
    v_mfma_f32_32x32x8_bf16 v[160:175], v[228:229], v[28:29], v[160:175]
    v_exp_f32 v148, v148
    v_exp_f32 v149, v149
    v_exp_f32 v150, v150
    v_exp_f32 v151, v151
    v_cvt_pk_bf16_f32 v66, v148, v149
    v_cvt_pk_bf16_f32 v67, v150, v151
    v_mfma_f32_32x32x16_bf16 v[128:143], v[232:235], v[72:75], v[128:143]
    v_exp_f32 v152, v152
    v_exp_f32 v153, v153
    v_exp_f32 v154, v154
    v_exp_f32 v155, v155
    v_cvt_pk_bf16_f32 v68, v152, v153
    v_cvt_pk_bf16_f32 v69, v154, v155
    v_mfma_f32_32x32x16_bf16 v[128:143], v[236:239], v[76:79], v[128:143]
    v_exp_f32 v156, v156
    v_exp_f32 v157, v157
    v_exp_f32 v158, v158
    v_exp_f32 v159, v159
    v_cvt_pk_bf16_f32 v70, v156, v157
    v_cvt_pk_bf16_f32 v71, v158, v159
    s_waitcnt lgkmcnt(0)
    v_mfma_f32_32x32x16_bf16 v[144:159], v[32:35], v[16:19], v[80:95]
    ds_read_b128 v[208:211], v2 offset:35840
    ds_read_b64 v[212:213], v3 offset:35840
    ds_read_b128 v[224:227], v2 offset:38400
    ds_read_b64 v[228:229], v3 offset:38400
    v_exp_f32 v160, v160
    v_exp_f32 v161, v161
    v_exp_f32 v162, v162
    v_exp_f32 v163, v163
    v_cvt_pk_bf16_f32 v72, v160, v161
    v_cvt_pk_bf16_f32 v73, v162, v163
    v_mfma_f32_32x32x8_bf16 v[144:159], v[36:37], v[20:21], v[144:159]
    s_mov_b64 exec, s[22:23]
    ds_read_b128 v[216:219], v4 offset:35840
    ds_read_b128 v[220:223], v4 offset:36480
    ds_read_b128 v[232:235], v4 offset:38400
    ds_read_b128 v[236:239], v4 offset:39040
    s_mov_b64 exec, -1
    v_exp_f32 v164, v164
    v_exp_f32 v165, v165
    v_exp_f32 v166, v166
    v_exp_f32 v167, v167
    v_cvt_pk_bf16_f32 v74, v164, v165
    v_cvt_pk_bf16_f32 v75, v166, v167
    v_mfma_f32_32x32x16_bf16 v[112:127], v[40:43], v[64:67], v[112:127]
    v_exp_f32 v168, v168
    v_exp_f32 v169, v169
    v_exp_f32 v170, v170
    v_exp_f32 v171, v171
    v_cvt_pk_bf16_f32 v76, v168, v169
    v_cvt_pk_bf16_f32 v77, v170, v171
    v_mfma_f32_32x32x16_bf16 v[112:127], v[44:47], v[68:71], v[112:127]
    v_exp_f32 v172, v172
    v_exp_f32 v173, v173
    v_exp_f32 v174, v174
    v_exp_f32 v175, v175
    v_cvt_pk_bf16_f32 v78, v172, v173
    v_cvt_pk_bf16_f32 v79, v174, v175
    v_mfma_f32_32x32x16_bf16 v[160:175], v[32:35], v[24:27], v[96:111]
    v_exp_f32 v144, v144
    v_exp_f32 v145, v145
    v_exp_f32 v146, v146
    v_exp_f32 v147, v147
    v_cvt_pk_bf16_f32 v64, v144, v145
    v_cvt_pk_bf16_f32 v65, v146, v147
    v_mfma_f32_32x32x8_bf16 v[160:175], v[36:37], v[28:29], v[160:175]
    v_exp_f32 v148, v148
    v_exp_f32 v149, v149
    v_exp_f32 v150, v150
    v_exp_f32 v151, v151
    v_cvt_pk_bf16_f32 v66, v148, v149
    v_cvt_pk_bf16_f32 v67, v150, v151
    v_mfma_f32_32x32x16_bf16 v[128:143], v[40:43], v[72:75], v[128:143]
    v_exp_f32 v152, v152
    v_exp_f32 v153, v153
    v_exp_f32 v154, v154
    v_exp_f32 v155, v155
    v_cvt_pk_bf16_f32 v68, v152, v153
    v_cvt_pk_bf16_f32 v69, v154, v155
    v_mfma_f32_32x32x16_bf16 v[128:143], v[44:47], v[76:79], v[128:143]
    v_exp_f32 v156, v156
    v_exp_f32 v157, v157
    v_exp_f32 v158, v158
    v_exp_f32 v159, v159
    v_cvt_pk_bf16_f32 v70, v156, v157
    v_cvt_pk_bf16_f32 v71, v158, v159
    v_mfma_f32_32x32x16_bf16 v[144:159], v[48:51], v[16:19], v[80:95]
    v_exp_f32 v160, v160
    v_exp_f32 v161, v161
    v_exp_f32 v162, v162
    v_exp_f32 v163, v163
    v_cvt_pk_bf16_f32 v72, v160, v161
    v_cvt_pk_bf16_f32 v73, v162, v163
    v_mfma_f32_32x32x8_bf16 v[144:159], v[52:53], v[20:21], v[144:159]
    v_exp_f32 v164, v164
    v_exp_f32 v165, v165
    v_exp_f32 v166, v166
    v_exp_f32 v167, v167
    v_cvt_pk_bf16_f32 v74, v164, v165
    v_cvt_pk_bf16_f32 v75, v166, v167
    v_mfma_f32_32x32x16_bf16 v[112:127], v[56:59], v[64:67], v[112:127]
    v_exp_f32 v168, v168
    v_exp_f32 v169, v169
    v_exp_f32 v170, v170
    v_exp_f32 v171, v171
    v_cvt_pk_bf16_f32 v76, v168, v169
    v_cvt_pk_bf16_f32 v77, v170, v171
    v_mfma_f32_32x32x16_bf16 v[112:127], v[60:63], v[68:71], v[112:127]
    v_exp_f32 v172, v172
    v_exp_f32 v173, v173
    v_exp_f32 v174, v174
    v_exp_f32 v175, v175
    v_cvt_pk_bf16_f32 v78, v172, v173
    v_cvt_pk_bf16_f32 v79, v174, v175
    v_mfma_f32_32x32x16_bf16 v[160:175], v[48:51], v[24:27], v[96:111]
    v_exp_f32 v144, v144
    v_exp_f32 v145, v145
    v_exp_f32 v146, v146
    v_exp_f32 v147, v147
    v_cvt_pk_bf16_f32 v64, v144, v145
    v_cvt_pk_bf16_f32 v65, v146, v147
    v_mfma_f32_32x32x8_bf16 v[160:175], v[52:53], v[28:29], v[160:175]
    v_exp_f32 v148, v148
    v_exp_f32 v149, v149
    v_exp_f32 v150, v150
    v_exp_f32 v151, v151
    v_cvt_pk_bf16_f32 v66, v148, v149
    v_cvt_pk_bf16_f32 v67, v150, v151
    v_mfma_f32_32x32x16_bf16 v[128:143], v[56:59], v[72:75], v[128:143]
    v_exp_f32 v152, v152
    v_exp_f32 v153, v153
    v_exp_f32 v154, v154
    v_exp_f32 v155, v155
    v_cvt_pk_bf16_f32 v68, v152, v153
    v_cvt_pk_bf16_f32 v69, v154, v155
    v_mfma_f32_32x32x16_bf16 v[128:143], v[60:63], v[76:79], v[128:143]
    v_exp_f32 v156, v156
    v_exp_f32 v157, v157
    v_exp_f32 v158, v158
    v_exp_f32 v159, v159
    v_cvt_pk_bf16_f32 v70, v156, v157
    v_cvt_pk_bf16_f32 v71, v158, v159
    s_waitcnt vmcnt(0) lgkmcnt(0)
    s_barrier
    v_add_u32 v2, s29, v2
    v_add_u32 v3, s29, v3
    v_add_u32 v4, s29, v4
    s_sub_u32 s29, 0, s29
    s_cmp_eq_u32 s26, 3
    s_cbranch_scc1 L_k2_nodma
    s_cmp_lt_u32 s12, 4
    s_cbranch_scc1 L_k2_adv
    s_cmp_eq_u32 s26, 2
    s_cbranch_scc1 L_k2_nokv
    s_add_u32 m0, s27, 0
    s_add_u32 s17, s28, 0
    buffer_load_dwordx4 v5, s[8:11], s17 offen lds
    s_add_u32 m0, s27, 1024
    s_add_u32 s17, s28, 1024
    buffer_load_dwordx4 v5, s[8:11], s17 offen lds
    s_add_u32 m0, s27, 2048
    s_add_u32 s17, s28, 2048
    buffer_load_dwordx4 v5, s[8:11], s17 offen lds
    s_add_u32 m0, s27, 3072
    s_add_u32 s17, s28, 3072
    buffer_load_dwordx4 v5, s[8:11], s17 offen lds
    s_add_u32 m0, s27, 4096
    s_add_u32 s17, s28, 4096
    buffer_load_dwordx4 v5, s[8:11], s17 offen lds
    s_add_u32 m0, s27, 4294946816
    s_add_u32 s17, s28, 4294946816
    buffer_load_dwordx4 v5, s[8:11], s17 offen lds
    s_add_u32 m0, s27, 4294947840
    s_add_u32 s17, s28, 4294947840
    buffer_load_dwordx4 v5, s[8:11], s17 offen lds
    s_add_u32 m0, s27, 4294948864
    s_add_u32 s17, s28, 4294948864
    buffer_load_dwordx4 v5, s[8:11], s17 offen lds
    s_add_u32 m0, s27, 4294949888
    s_add_u32 s17, s28, 4294949888
    buffer_load_dwordx4 v5, s[8:11], s17 offen lds
    s_add_u32 m0, s27, 4294950912
    s_add_u32 s17, s28, 4294950912
    buffer_load_dwordx4 v5, s[8:11], s17 offen lds
    s_cmp_eq_u32 s26, 0
    s_cselect_b32 s60, s6, s40
    s_cselect_b32 s61, s7, s41
    s_and_b32 s61, s61, 0xffff
    s_mov_b32 s62, 819200
    s_mov_b32 s63, 0x00020000
    s_lshr_b32 s17, s2, 3
    s_lshl_b32 s17, s17, 2
    s_add_u32 s17, s17, s12
    s_sub_u32 s17, s17, 4
    s_mul_i32 s17, s17, 6400
    v_lshlrev_b32 v15, 7, v1
    buffer_load_dword v15, v15, s[60:63], s17 offen
L_k2_nokv:
    s_add_u32 m0, s53, 0
    s_nop 0
    buffer_load_dwordx4 v192, s[44:47], s52 offen lds
    s_add_u32 m0, s53, 1024
    s_nop 0
    buffer_load_dwordx4 v193, s[44:47], s52 offen lds
    s_add_u32 m0, s53, 2048
    s_nop 0
    buffer_load_dwordx4 v194, s[44:47], s52 offen lds
    s_add_u32 m0, s53, 3072
    s_nop 0
    buffer_load_dwordx4 v195, s[44:47], s52 offen lds
    s_add_u32 m0, s53, 4096
    s_nop 0
    buffer_load_dwordx4 v196, s[44:47], s52 offen lds
    s_sub_u32 s52, s52, 51200
    s_sub_u32 s18, s53, 20480
    s_add_u32 m0, s18, 0
    s_nop 0
    buffer_load_dwordx4 v192, s[44:47], s52 offen lds
    s_add_u32 m0, s18, 1024
    s_nop 0
    buffer_load_dwordx4 v193, s[44:47], s52 offen lds
    s_add_u32 m0, s18, 2048
    s_nop 0
    buffer_load_dwordx4 v194, s[44:47], s52 offen lds
    s_add_u32 m0, s18, 3072
    s_nop 0
    buffer_load_dwordx4 v195, s[44:47], s52 offen lds
    s_add_u32 m0, s18, 4096
    s_nop 0
    buffer_load_dwordx4 v196, s[44:47], s52 offen lds
    s_add_u32 s52, s52, 51200
L_k2_adv:
    s_add_u32 s28, s28, 40960
    s_xor_b32 s27, s27, s33
    s_add_u32 s52, s52, 102400
    s_add_u32 s53, s53, 40960
    s_cmp_ge_u32 s53, 163840
    s_cselect_b32 s17, 163840, 0
    s_sub_u32 s53, s53, s17
L_k2_nodma:
    v_mfma_f32_32x32x16_bf16 v[144:159], v[208:211], v[16:19], v[80:95]
    ds_read_b128 v[32:35], v2 offset:0
    ds_read_b64 v[36:37], v3 offset:0
    ds_read_b128 v[48:51], v2 offset:2560
    ds_read_b64 v[52:53], v3 offset:2560
    v_exp_f32 v160, v160
    v_exp_f32 v161, v161
    v_exp_f32 v162, v162
    v_exp_f32 v163, v163
    v_cvt_pk_bf16_f32 v72, v160, v161
    v_cvt_pk_bf16_f32 v73, v162, v163
    v_mfma_f32_32x32x8_bf16 v[144:159], v[212:213], v[20:21], v[144:159]
    s_mov_b64 exec, s[22:23]
    ds_read_b128 v[40:43], v4 offset:0
    ds_read_b128 v[44:47], v4 offset:640
    ds_read_b128 v[56:59], v4 offset:2560
    ds_read_b128 v[60:63], v4 offset:3200
    s_mov_b64 exec, -1
    v_exp_f32 v164, v164
    v_exp_f32 v165, v165
    v_exp_f32 v166, v166
    v_exp_f32 v167, v167
    v_cvt_pk_bf16_f32 v74, v164, v165
    v_cvt_pk_bf16_f32 v75, v166, v167
    v_mfma_f32_32x32x16_bf16 v[112:127], v[216:219], v[64:67], v[112:127]
    v_exp_f32 v168, v168
    v_exp_f32 v169, v169
    v_exp_f32 v170, v170
    v_exp_f32 v171, v171
    v_cvt_pk_bf16_f32 v76, v168, v169
    v_cvt_pk_bf16_f32 v77, v170, v171
    v_mfma_f32_32x32x16_bf16 v[112:127], v[220:223], v[68:71], v[112:127]
    v_exp_f32 v172, v172
    v_exp_f32 v173, v173
    v_exp_f32 v174, v174
    v_exp_f32 v175, v175
    v_cvt_pk_bf16_f32 v78, v172, v173
    v_cvt_pk_bf16_f32 v79, v174, v175
    v_mfma_f32_32x32x16_bf16 v[160:175], v[208:211], v[24:27], v[96:111]
    v_exp_f32 v144, v144
    v_exp_f32 v145, v145
    v_exp_f32 v146, v146
    v_exp_f32 v147, v147
    v_cvt_pk_bf16_f32 v64, v144, v145
    v_cvt_pk_bf16_f32 v65, v146, v147
    v_mfma_f32_32x32x8_bf16 v[160:175], v[212:213], v[28:29], v[160:175]
    v_exp_f32 v148, v148
    v_exp_f32 v149, v149
    v_exp_f32 v150, v150
    v_exp_f32 v151, v151
    v_cvt_pk_bf16_f32 v66, v148, v149
    v_cvt_pk_bf16_f32 v67, v150, v151
    v_mfma_f32_32x32x16_bf16 v[128:143], v[216:219], v[72:75], v[128:143]
    v_exp_f32 v152, v152
    v_exp_f32 v153, v153
    v_exp_f32 v154, v154
    v_exp_f32 v155, v155
    v_cvt_pk_bf16_f32 v68, v152, v153
    v_cvt_pk_bf16_f32 v69, v154, v155
    v_mfma_f32_32x32x16_bf16 v[128:143], v[220:223], v[76:79], v[128:143]
    v_exp_f32 v156, v156
    v_exp_f32 v157, v157
    v_exp_f32 v158, v158
    v_exp_f32 v159, v159
    v_cvt_pk_bf16_f32 v70, v156, v157
    v_cvt_pk_bf16_f32 v71, v158, v159
    v_mfma_f32_32x32x16_bf16 v[144:159], v[224:227], v[16:19], v[80:95]
    v_exp_f32 v160, v160
    v_exp_f32 v161, v161
    v_exp_f32 v162, v162
    v_exp_f32 v163, v163
    v_cvt_pk_bf16_f32 v72, v160, v161
    v_cvt_pk_bf16_f32 v73, v162, v163
    v_mfma_f32_32x32x8_bf16 v[144:159], v[228:229], v[20:21], v[144:159]
    v_exp_f32 v164, v164
    v_exp_f32 v165, v165
    v_exp_f32 v166, v166
    v_exp_f32 v167, v167
    v_cvt_pk_bf16_f32 v74, v164, v165
    v_cvt_pk_bf16_f32 v75, v166, v167
    v_mfma_f32_32x32x16_bf16 v[112:127], v[232:235], v[64:67], v[112:127]
    v_exp_f32 v168, v168
    v_exp_f32 v169, v169
    v_exp_f32 v170, v170
    v_exp_f32 v171, v171
    v_cvt_pk_bf16_f32 v76, v168, v169
    v_cvt_pk_bf16_f32 v77, v170, v171
    v_mfma_f32_32x32x16_bf16 v[112:127], v[236:239], v[68:71], v[112:127]
    v_exp_f32 v172, v172
    v_exp_f32 v173, v173
    v_exp_f32 v174, v174
    v_exp_f32 v175, v175
    v_cvt_pk_bf16_f32 v78, v172, v173
    v_cvt_pk_bf16_f32 v79, v174, v175
    s_add_u32 s26, s26, 1
    s_cmp_lt_u32 s26, 4
    s_cbranch_scc1 L_k2_stage
    s_nop 1
    v_mfma_f32_32x32x16_bf16 v[128:143], v[232:235], v[72:75], v[128:143]
    v_mfma_f32_32x32x16_bf16 v[128:143], v[236:239], v[76:79], v[128:143]
    s_lshr_b32 s17, s15, 4
    s_mul_i32 s17, s17, 10
    s_and_b32 s18, s15, 15
    s_lshr_b32 s19, s18, 1
    s_add_u32 s19, s19, s17
    s_lshl_b32 s19, s19, 10
    s_and_b32 s20, s18, 1
    s_lshl_b32 s20, s20, 9
    s_add_u32 s19, s19, s20
    s_lshr_b32 s20, s18, 3
    s_add_u32 s17, s17, s20
    s_add_u32 s17, s17, 8
    s_lshl_b32 s17, s17, 10
    s_bfe_u32 s20, s18, 0x20001
    s_lshl_b32 s20, s20, 8
    s_add_u32 s17, s17, s20
    s_and_b32 s20, s18, 1
    s_lshl_b32 s20, s20, 3
    s_add_u32 s17, s17, s20
    s_mul_i32 s18, s16, 81920
    s_add_u32 s18, s18, 12582912
    s_add_u32 s36, s19, s18
    s_add_u32 s37, s36, 81920
    s_add_u32 s38, s17, s18
    s_add_u32 s39, s38, 81920
    v_lshrrev_b32 v15, 4, v10
    v_mul_u32_u24 v15, 40960, v15
    v_and_b32 v14, 15, v1
    v_lshl_add_u32 v15, v14, 4, v15
    v_lshrrev_b32 v14, 5, v1
    v_lshl_add_u32 v15, v14, 8, v15
    s_waitcnt lgkmcnt(0)
L_k2_epi:
    v_mov_b32 v13, v120
    v_mov_b32 v144, v120
    v_mov_b32 v14, v136
    v_mov_b32 v145, v136
    s_nop 1
    v_permlane32_swap_b32 v13, v144
    v_permlane32_swap_b32 v14, v145
    v_min_f32 v13, v144, v145
    s_mov_b32 s17, 0x1f800000
    v_cmp_nle_f32 vcc, s17, v13
    v_cmp_u_f32 s[34:35], v144, v145
    s_or_b64 vcc, vcc, s[34:35]
    s_cmp_eq_u64 vcc, 0
    s_cbranch_scc1 L_k2_out
    s_cmp_eq_u32 s30, 0
    s_cbranch_scc1 L_k2_slow
L_k2_out:
    v_rcp_f32 v144, v144
    s_nop 0
    v_mul_f32 v144, v144, v8
    v_mul_f32 v112, v112, v144
    v_mul_f32 v113, v113, v144
    v_mul_f32 v114, v114, v144
    v_mul_f32 v115, v115, v144
    v_mul_f32 v116, v116, v144
    v_mul_f32 v117, v117, v144
    v_mul_f32 v118, v118, v144
    v_mul_f32 v119, v119, v144
    v_mul_f32 v120, v120, v144
    v_mul_f32 v121, v121, v144
    v_mul_f32 v122, v122, v144
    v_mul_f32 v123, v123, v144
    v_cvt_pk_bf16_f32 v112, v112, v113
    v_cvt_pk_bf16_f32 v113, v114, v115
    v_cvt_pk_bf16_f32 v114, v116, v117
    v_cvt_pk_bf16_f32 v115, v118, v119
    v_cvt_pk_bf16_f32 v116, v120, v121
    v_cvt_pk_bf16_f32 v117, v122, v123
    s_nop 0
    v_permlane32_swap_b32 v112, v114
    v_permlane32_swap_b32 v113, v115
    buffer_store_dwordx4 v[112:115], v15, s[8:11], s36 offen sc1
    s_mov_b64 exec, s[24:25]
    buffer_store_dwordx2 v[116:117], v15, s[8:11], s38 offen sc1
    s_mov_b64 exec, -1
    v_rcp_f32 v145, v145
    s_nop 0
    v_mul_f32 v145, v145, v9
    v_mul_f32 v128, v128, v145
    v_mul_f32 v129, v129, v145
    v_mul_f32 v130, v130, v145
    v_mul_f32 v131, v131, v145
    v_mul_f32 v132, v132, v145
    v_mul_f32 v133, v133, v145
    v_mul_f32 v134, v134, v145
    v_mul_f32 v135, v135, v145
    v_mul_f32 v136, v136, v145
    v_mul_f32 v137, v137, v145
    v_mul_f32 v138, v138, v145
    v_mul_f32 v139, v139, v145
    v_cvt_pk_bf16_f32 v128, v128, v129
    v_cvt_pk_bf16_f32 v129, v130, v131
    v_cvt_pk_bf16_f32 v130, v132, v133
    v_cvt_pk_bf16_f32 v131, v134, v135
    v_cvt_pk_bf16_f32 v132, v136, v137
    v_cvt_pk_bf16_f32 v133, v138, v139
    s_nop 0
    v_permlane32_swap_b32 v128, v130
    v_permlane32_swap_b32 v129, v131
    buffer_store_dwordx4 v[128:131], v15, s[8:11], s37 offen sc1
    s_mov_b64 exec, s[24:25]
    buffer_store_dwordx2 v[132:133], v15, s[8:11], s39 offen sc1
    s_mov_b64 exec, -1
    v_and_b32 v10, 15, v1
    v_lshrrev_b32 v11, 4, v1
    v_lshrrev_b32 v12, 2, v10
    v_lshl_add_u32 v12, v11, 2, v12
    v_mul_u32_u24 v12, 160, v12
    v_and_b32 v13, 3, v1
    v_lshlrev_b32 v13, 3, v13
    s_and_b32 s20, s12, 3
    s_mul_i32 s17, s20, 5120
    v_add3_u32 v16, v12, v13, s17
    v_add_u32 v17, 81920, v16
    ds_read_b64_tr_b16 v[32:33], v17 offset:0
    ds_read_b64_tr_b16 v[34:35], v17 offset:2560
    ds_read_b64_tr_b16 v[36:37], v17 offset:32
    ds_read_b64_tr_b16 v[38:39], v17 offset:2592
    ds_read_b64_tr_b16 v[40:41], v17 offset:64
    ds_read_b64_tr_b16 v[42:43], v17 offset:2624
    ds_read_b64_tr_b16 v[44:45], v17 offset:96
    ds_read_b64_tr_b16 v[46:47], v17 offset:2656
    ds_read_b64_tr_b16 v[48:49], v17 offset:128
    ds_read_b64_tr_b16 v[50:51], v17 offset:2688
    s_waitcnt lgkmcnt(4)
    ds_read_b64_tr_b16 v[52:53], v17 offset:20480
    ds_read_b64_tr_b16 v[54:55], v17 offset:23040
    ds_read_b64_tr_b16 v[56:57], v17 offset:20512
    ds_read_b64_tr_b16 v[58:59], v17 offset:23072
    ds_read_b64_tr_b16 v[60:61], v17 offset:20544
    ds_read_b64_tr_b16 v[62:63], v17 offset:23104
    ds_read_b64_tr_b16 v[64:65], v17 offset:20576
    ds_read_b64_tr_b16 v[66:67], v17 offset:23136
    ds_read_b64_tr_b16 v[68:69], v17 offset:20608
    ds_read_b64_tr_b16 v[70:71], v17 offset:23168
    v_mov_b32 v72, 0
    v_mov_b32 v73, 0
    v_mov_b32 v74, 0
    v_mov_b32 v75, 0
    v_mov_b32 v76, 0
    v_mov_b32 v77, 0
    v_mov_b32 v78, 0
    v_mov_b32 v79, 0
    v_mov_b32 v80, 0
    v_mov_b32 v81, 0
    v_mov_b32 v82, 0
    v_mov_b32 v83, 0
    v_mov_b32 v84, 0
    v_mov_b32 v85, 0
    v_mov_b32 v86, 0
    v_mov_b32 v87, 0
    v_mov_b32 v88, 0
    v_mov_b32 v89, 0
    v_mov_b32 v90, 0
    v_mov_b32 v91, 0
    v_mov_b32 v92, 0
    v_mov_b32 v93, 0
    v_mov_b32 v94, 0
    v_mov_b32 v95, 0
    v_mov_b32 v96, 0
    v_mov_b32 v97, 0
    v_mov_b32 v98, 0
    v_mov_b32 v99, 0
    v_mov_b32 v100, 0
    v_mov_b32 v101, 0
    v_mov_b32 v102, 0
    v_mov_b32 v103, 0
    v_mov_b32 v104, 0
    v_mov_b32 v105, 0
    v_mov_b32 v106, 0
    v_mov_b32 v107, 0
    v_mov_b32 v108, 0
    v_mov_b32 v109, 0
    v_mov_b32 v110, 0
    v_mov_b32 v111, 0
    s_lshr_b32 s18, s12, 2
    s_lshl_b32 s17, s54, 2
    s_lshl_b32 s19, s18, 1
    s_add_u32 s17, s17, s19
    s_mul_i32 s17, s17, 40960
    s_mul_i32 s19, s20, 10240
    s_add_u32 s17, s17, s19
    s_add_u32 s56, s17, 12582912
    s_add_u32 s57, s56, 40960
    s_lshl_b32 s58, s21, 12
    s_add_u32 s58, s58, 11665408
    s_waitcnt vmcnt(0) lgkmcnt(0)
    s_barrier
    s_cmp_lg_u32 s12, 0
    s_cbranch_scc1 L_k2_nosig
    s_lshl_b32 s17, s59, 7
    v_lshlrev_b32 v12, 9, v1
    v_add_u32 v12, s17, v12
    v_mov_b32 v13, 1
    s_mov_b64 exec, 0xff
    buffer_atomic_add v13, v12, s[8:11], s58 offen sc1
    s_mov_b64 exec, -1
L_k2_nosig:
    s_add_u32 m0, s53, 0
    s_nop 0
    buffer_load_dwordx4 v192, s[44:47], s52 offen lds
    s_add_u32 m0, s53, 1024
    s_nop 0
    buffer_load_dwordx4 v193, s[44:47], s52 offen lds
    s_add_u32 m0, s53, 2048
    s_nop 0
    buffer_load_dwordx4 v194, s[44:47], s52 offen lds
    s_add_u32 m0, s53, 3072
    s_nop 0
    buffer_load_dwordx4 v195, s[44:47], s52 offen lds
    s_add_u32 m0, s53, 4096
    s_nop 0
    buffer_load_dwordx4 v196, s[44:47], s52 offen lds
    s_and_b32 s17, s12, 1
    s_mul_i32 s17, s17, 320
    s_mul_i32 s18, s18, 160
    s_add_u32 s17, s17, s18
    s_mul_i32 s52, s17, 1280
    s_mul_i32 s17, s55, 160
    s_add_u32 s52, s52, s17
    s_add_u32 s53, s53, 40960
    s_add_u32 m0, s53, 0
    s_nop 0
    buffer_load_dwordx4 v197, s[44:47], s52 offen lds
    s_add_u32 m0, s53, 1024
    s_nop 0
    buffer_load_dwordx4 v198, s[44:47], s52 offen lds
    s_add_u32 m0, s53, 2048
    s_nop 0
    buffer_load_dwordx4 v199, s[44:47], s52 offen lds
    s_add_u32 m0, s53, 3072
    s_nop 0
    buffer_load_dwordx4 v200, s[44:47], s52 offen lds
    s_add_u32 m0, s53, 4096
    s_nop 0
    buffer_load_dwordx4 v201, s[44:47], s52 offen lds
    s_mov_b32 s48, s42
    s_and_b32 s49, s43, 0xffff
    s_mov_b32 s50, 2621440
    s_mov_b32 s51, 0x00020000
    s_lshr_b32 s18, s12, 2
    s_mul_i32 s17, s18, 10752
    s_mul_i32 s19, s20, 21504
    s_add_u32 s17, s17, s19
    v_mul_u32_u24 v12, 336, v10
    v_lshlrev_b32 v13, 4, v11
    v_add3_u32 v18, v12, v13, s17
    v_add_u32 v12, 0, v0
    v_mul_u32_u24 v13, 205, v12
    v_lshrrev_b32 v13, 11, v13
    v_mul_u32_u24 v14, 10, v13
    v_sub_u32 v14, v12, v14
    v_mul_u32_u24 v12, 336, v13
    v_lshl_add_u32 v20, v14, 5, v12
    v_mul_u32_u24 v12, 1280, v13
    v_lshl_add_u32 v22, v14, 4, v12
    v_add_u32 v12, 512, v0
    v_mul_u32_u24 v13, 205, v12
    v_lshrrev_b32 v13, 11, v13
    v_mul_u32_u24 v14, 10, v13
    v_sub_u32 v14, v12, v14
    v_mul_u32_u24 v12, 336, v13
    v_lshl_add_u32 v21, v14, 5, v12
    v_mul_u32_u24 v12, 1280, v13
    v_lshl_add_u32 v23, v14, 4, v12
    s_mul_i32 s17, s54, 81920
    s_mul_i32 s18, s55, 160
    s_add_u32 s36, s17, s18
    s_mul_i32 s38, s54, 163840
    s_lshl_b32 s17, s55, 3
    s_add_u32 s17, s17, s12
    s_mul_i32 s17, s17, 2560
    s_add_u32 s38, s38, s17
    s_add_u32 s38, s38, 12582912
    v_min_u32 v25, 19, v1
    v_lshlrev_b32 v25, 7, v25
    s_cmp_lg_u32 s12, 0
    s_cbranch_scc1 L_k2_polled
    v_and_b32 v12, 3, v1
    v_lshlrev_b32 v12, 7, v12
    s_and_b32 s17, s54, 7
    s_lshl_b32 s17, s17, 9
    s_add_u32 s58, s58, s17
    s_mov_b32 s17, 400000
L_k2_poll:
    buffer_load_dword v13, v12, s[8:11], s58 offen sc1
    s_waitcnt vmcnt(0)
    v_cmp_gt_u32 vcc, 16, v13
    s_cmp_eq_u64 vcc, 0
    s_cbranch_scc1 L_k2_polled
    s_sub_u32 s17, s17, 1
    s_cmp_lg_u32 s17, 0
    s_cbranch_scc1 L_k2_poll
L_k2_polled:
    s_waitcnt vmcnt(0)
    s_barrier
    buffer_load_dwordx4 v[112:115], v5, s[8:11], s56 offen offset:0 sc1
    buffer_load_dwordx4 v[116:119], v5, s[8:11], s57 offen offset:0 sc1
    buffer_load_dwordx4 v[120:123], v5, s[8:11], s56 offen offset:1024 sc1
    buffer_load_dwordx4 v[124:127], v5, s[8:11], s57 offen offset:1024 sc1
    s_waitcnt vmcnt(2) lgkmcnt(0)
    buffer_load_dwordx4 v[128:131], v5, s[8:11], s56 offen offset:2048 sc1
    buffer_load_dwordx4 v[132:135], v5, s[8:11], s57 offen offset:2048 sc1
    v_mfma_f32_16x16x32_bf16 v[72:75], v[32:35], v[112:115], v[72:75]
    v_mfma_f32_16x16x32_bf16 v[92:95], v[32:35], v[116:119], v[92:95]
    v_mfma_f32_16x16x32_bf16 v[76:79], v[36:39], v[112:115], v[76:79]
    v_mfma_f32_16x16x32_bf16 v[96:99], v[36:39], v[116:119], v[96:99]
    v_mfma_f32_16x16x32_bf16 v[80:83], v[40:43], v[112:115], v[80:83]
    v_mfma_f32_16x16x32_bf16 v[100:103], v[40:43], v[116:119], v[100:103]
    v_mfma_f32_16x16x32_bf16 v[84:87], v[44:47], v[112:115], v[84:87]
    v_mfma_f32_16x16x32_bf16 v[104:107], v[44:47], v[116:119], v[104:107]
    v_mfma_f32_16x16x32_bf16 v[88:91], v[48:51], v[112:115], v[88:91]
    v_mfma_f32_16x16x32_bf16 v[108:111], v[48:51], v[116:119], v[108:111]
    ds_read_b64_tr_b16 v[32:33], v17 offset:40960
    ds_read_b64_tr_b16 v[34:35], v17 offset:43520
    ds_read_b64_tr_b16 v[36:37], v17 offset:40992
    ds_read_b64_tr_b16 v[38:39], v17 offset:43552
    ds_read_b64_tr_b16 v[40:41], v17 offset:41024
    ds_read_b64_tr_b16 v[42:43], v17 offset:43584
    ds_read_b64_tr_b16 v[44:45], v17 offset:41056
    ds_read_b64_tr_b16 v[46:47], v17 offset:43616
    ds_read_b64_tr_b16 v[48:49], v17 offset:41088
    ds_read_b64_tr_b16 v[50:51], v17 offset:43648
    s_waitcnt vmcnt(2) lgkmcnt(10)
    buffer_load_dwordx4 v[136:139], v5, s[8:11], s56 offen offset:3072 sc1
    buffer_load_dwordx4 v[140:143], v5, s[8:11], s57 offen offset:3072 sc1
    s_add_u32 s56, s56, 4096
    s_add_u32 s57, s57, 4096
    v_mfma_f32_16x16x32_bf16 v[72:75], v[52:55], v[120:123], v[72:75]
    v_mfma_f32_16x16x32_bf16 v[92:95], v[52:55], v[124:127], v[92:95]
    v_mfma_f32_16x16x32_bf16 v[76:79], v[56:59], v[120:123], v[76:79]
    v_mfma_f32_16x16x32_bf16 v[96:99], v[56:59], v[124:127], v[96:99]
    v_mfma_f32_16x16x32_bf16 v[80:83], v[60:63], v[120:123], v[80:83]
    v_mfma_f32_16x16x32_bf16 v[100:103], v[60:63], v[124:127], v[100:103]
    v_mfma_f32_16x16x32_bf16 v[84:87], v[64:67], v[120:123], v[84:87]
    v_mfma_f32_16x16x32_bf16 v[104:107], v[64:67], v[124:127], v[104:107]
    v_mfma_f32_16x16x32_bf16 v[88:91], v[68:71], v[120:123], v[88:91]
    v_mfma_f32_16x16x32_bf16 v[108:111], v[68:71], v[124:127], v[108:111]
    ds_read_b64_tr_b16 v[52:53], v17 offset:61440
    ds_read_b64_tr_b16 v[54:55], v17 offset:64000
    ds_read_b64_tr_b16 v[56:57], v17 offset:61472
    ds_read_b64_tr_b16 v[58:59], v17 offset:64032
    ds_read_b64_tr_b16 v[60:61], v17 offset:61504
    ds_read_b64_tr_b16 v[62:63], v17 offset:64064
    ds_read_b64_tr_b16 v[64:65], v17 offset:61536
    ds_read_b64_tr_b16 v[66:67], v17 offset:64096
    ds_read_b64_tr_b16 v[68:69], v17 offset:61568
    ds_read_b64_tr_b16 v[70:71], v17 offset:64128
    s_waitcnt vmcnt(2) lgkmcnt(10)
    buffer_load_dwordx4 v[144:147], v5, s[8:11], s56 offen offset:0 sc1
    buffer_load_dwordx4 v[148:151], v5, s[8:11], s57 offen offset:0 sc1
    v_mfma_f32_16x16x32_bf16 v[72:75], v[32:35], v[128:131], v[72:75]
    v_mfma_f32_16x16x32_bf16 v[92:95], v[32:35], v[132:135], v[92:95]
    v_mfma_f32_16x16x32_bf16 v[76:79], v[36:39], v[128:131], v[76:79]
    v_mfma_f32_16x16x32_bf16 v[96:99], v[36:39], v[132:135], v[96:99]
    v_mfma_f32_16x16x32_bf16 v[80:83], v[40:43], v[128:131], v[80:83]
    v_mfma_f32_16x16x32_bf16 v[100:103], v[40:43], v[132:135], v[100:103]
    v_mfma_f32_16x16x32_bf16 v[84:87], v[44:47], v[128:131], v[84:87]
    v_mfma_f32_16x16x32_bf16 v[104:107], v[44:47], v[132:135], v[104:107]
    v_mfma_f32_16x16x32_bf16 v[88:91], v[48:51], v[128:131], v[88:91]
    v_mfma_f32_16x16x32_bf16 v[108:111], v[48:51], v[132:135], v[108:111]
    ds_read_b64_tr_b16 v[32:33], v16 offset:0
    ds_read_b64_tr_b16 v[34:35], v16 offset:2560
    ds_read_b64_tr_b16 v[36:37], v16 offset:32
    ds_read_b64_tr_b16 v[38:39], v16 offset:2592
    ds_read_b64_tr_b16 v[40:41], v16 offset:64
    ds_read_b64_tr_b16 v[42:43], v16 offset:2624
    ds_read_b64_tr_b16 v[44:45], v16 offset:96
    ds_read_b64_tr_b16 v[46:47], v16 offset:2656
    ds_read_b64_tr_b16 v[48:49], v16 offset:128
    ds_read_b64_tr_b16 v[50:51], v16 offset:2688
    s_waitcnt vmcnt(2) lgkmcnt(10)
    buffer_load_dwordx4 v[152:155], v5, s[8:11], s56 offen offset:1024 sc1
    buffer_load_dwordx4 v[156:159], v5, s[8:11], s57 offen offset:1024 sc1
    v_mfma_f32_16x16x32_bf16 v[72:75], v[52:55], v[136:139], v[72:75]
    v_mfma_f32_16x16x32_bf16 v[92:95], v[52:55], v[140:143], v[92:95]
    v_mfma_f32_16x16x32_bf16 v[76:79], v[56:59], v[136:139], v[76:79]
    v_mfma_f32_16x16x32_bf16 v[96:99], v[56:59], v[140:143], v[96:99]
    v_mfma_f32_16x16x32_bf16 v[80:83], v[60:63], v[136:139], v[80:83]
    v_mfma_f32_16x16x32_bf16 v[100:103], v[60:63], v[140:143], v[100:103]
    v_mfma_f32_16x16x32_bf16 v[84:87], v[64:67], v[136:139], v[84:87]
    v_mfma_f32_16x16x32_bf16 v[104:107], v[64:67], v[140:143], v[104:107]
    v_mfma_f32_16x16x32_bf16 v[88:91], v[68:71], v[136:139], v[88:91]
    v_mfma_f32_16x16x32_bf16 v[108:111], v[68:71], v[140:143], v[108:111]
    ds_read_b64_tr_b16 v[52:53], v16 offset:20480
    ds_read_b64_tr_b16 v[54:55], v16 offset:23040
    ds_read_b64_tr_b16 v[56:57], v16 offset:20512
    ds_read_b64_tr_b16 v[58:59], v16 offset:23072
    ds_read_b64_tr_b16 v[60:61], v16 offset:20544
    ds_read_b64_tr_b16 v[62:63], v16 offset:23104
    ds_read_b64_tr_b16 v[64:65], v16 offset:20576
    ds_read_b64_tr_b16 v[66:67], v16 offset:23136
    ds_read_b64_tr_b16 v[68:69], v16 offset:20608
    ds_read_b64_tr_b16 v[70:71], v16 offset:23168
    s_waitcnt vmcnt(2) lgkmcnt(10)
    buffer_load_dwordx4 v[160:163], v5, s[8:11], s56 offen offset:2048 sc1
    buffer_load_dwordx4 v[164:167], v5, s[8:11], s57 offen offset:2048 sc1
    v_mfma_f32_16x16x32_bf16 v[72:75], v[32:35], v[144:147], v[72:75]
    v_mfma_f32_16x16x32_bf16 v[92:95], v[32:35], v[148:151], v[92:95]
    v_mfma_f32_16x16x32_bf16 v[76:79], v[36:39], v[144:147], v[76:79]
    v_mfma_f32_16x16x32_bf16 v[96:99], v[36:39], v[148:151], v[96:99]
    v_mfma_f32_16x16x32_bf16 v[80:83], v[40:43], v[144:147], v[80:83]
    v_mfma_f32_16x16x32_bf16 v[100:103], v[40:43], v[148:151], v[100:103]
    v_mfma_f32_16x16x32_bf16 v[84:87], v[44:47], v[144:147], v[84:87]
    v_mfma_f32_16x16x32_bf16 v[104:107], v[44:47], v[148:151], v[104:107]
    v_mfma_f32_16x16x32_bf16 v[88:91], v[48:51], v[144:147], v[88:91]
    v_mfma_f32_16x16x32_bf16 v[108:111], v[48:51], v[148:151], v[108:111]
    ds_read_b64_tr_b16 v[32:33], v16 offset:40960
    ds_read_b64_tr_b16 v[34:35], v16 offset:43520
    ds_read_b64_tr_b16 v[36:37], v16 offset:40992
    ds_read_b64_tr_b16 v[38:39], v16 offset:43552
    ds_read_b64_tr_b16 v[40:41], v16 offset:41024
    ds_read_b64_tr_b16 v[42:43], v16 offset:43584
    ds_read_b64_tr_b16 v[44:45], v16 offset:41056
    ds_read_b64_tr_b16 v[46:47], v16 offset:43616
    ds_read_b64_tr_b16 v[48:49], v16 offset:41088
    ds_read_b64_tr_b16 v[50:51], v16 offset:43648
    s_waitcnt vmcnt(2) lgkmcnt(10)
    buffer_load_dwordx4 v[168:171], v5, s[8:11], s56 offen offset:3072 sc1
    buffer_load_dwordx4 v[172:175], v5, s[8:11], s57 offen offset:3072 sc1
    s_add_u32 s56, s56, 4096
    s_add_u32 s57, s57, 4096
    v_mfma_f32_16x16x32_bf16 v[72:75], v[52:55], v[152:155], v[72:75]
    v_mfma_f32_16x16x32_bf16 v[92:95], v[52:55], v[156:159], v[92:95]
    v_mfma_f32_16x16x32_bf16 v[76:79], v[56:59], v[152:155], v[76:79]
    v_mfma_f32_16x16x32_bf16 v[96:99], v[56:59], v[156:159], v[96:99]
    v_mfma_f32_16x16x32_bf16 v[80:83], v[60:63], v[152:155], v[80:83]
    v_mfma_f32_16x16x32_bf16 v[100:103], v[60:63], v[156:159], v[100:103]
    v_mfma_f32_16x16x32_bf16 v[84:87], v[64:67], v[152:155], v[84:87]
    v_mfma_f32_16x16x32_bf16 v[104:107], v[64:67], v[156:159], v[104:107]
    v_mfma_f32_16x16x32_bf16 v[88:91], v[68:71], v[152:155], v[88:91]
    v_mfma_f32_16x16x32_bf16 v[108:111], v[68:71], v[156:159], v[108:111]
    ds_read_b64_tr_b16 v[52:53], v16 offset:61440
    ds_read_b64_tr_b16 v[54:55], v16 offset:64000
    ds_read_b64_tr_b16 v[56:57], v16 offset:61472
    ds_read_b64_tr_b16 v[58:59], v16 offset:64032
    ds_read_b64_tr_b16 v[60:61], v16 offset:61504
    ds_read_b64_tr_b16 v[62:63], v16 offset:64064
    ds_read_b64_tr_b16 v[64:65], v16 offset:61536
    ds_read_b64_tr_b16 v[66:67], v16 offset:64096
    ds_read_b64_tr_b16 v[68:69], v16 offset:61568
    ds_read_b64_tr_b16 v[70:71], v16 offset:64128
    s_waitcnt vmcnt(2) lgkmcnt(10)
    buffer_load_dwordx4 v[176:179], v5, s[8:11], s56 offen offset:0 sc1
    buffer_load_dwordx4 v[180:183], v5, s[8:11], s57 offen offset:0 sc1
    v_mfma_f32_16x16x32_bf16 v[72:75], v[32:35], v[160:163], v[72:75]
    v_mfma_f32_16x16x32_bf16 v[92:95], v[32:35], v[164:167], v[92:95]
    v_mfma_f32_16x16x32_bf16 v[76:79], v[36:39], v[160:163], v[76:79]
    v_mfma_f32_16x16x32_bf16 v[96:99], v[36:39], v[164:167], v[96:99]
    v_mfma_f32_16x16x32_bf16 v[80:83], v[40:43], v[160:163], v[80:83]
    v_mfma_f32_16x16x32_bf16 v[100:103], v[40:43], v[164:167], v[100:103]
    v_mfma_f32_16x16x32_bf16 v[84:87], v[44:47], v[160:163], v[84:87]
    v_mfma_f32_16x16x32_bf16 v[104:107], v[44:47], v[164:167], v[104:107]
    v_mfma_f32_16x16x32_bf16 v[88:91], v[48:51], v[160:163], v[88:91]
    v_mfma_f32_16x16x32_bf16 v[108:111], v[48:51], v[164:167], v[108:111]
    ds_read_b64_tr_b16 v[32:33], v17 offset:0
    ds_read_b64_tr_b16 v[34:35], v17 offset:2560
    ds_read_b64_tr_b16 v[36:37], v17 offset:32
    ds_read_b64_tr_b16 v[38:39], v17 offset:2592
    ds_read_b64_tr_b16 v[40:41], v17 offset:64
    ds_read_b64_tr_b16 v[42:43], v17 offset:2624
    ds_read_b64_tr_b16 v[44:45], v17 offset:96
    ds_read_b64_tr_b16 v[46:47], v17 offset:2656
    ds_read_b64_tr_b16 v[48:49], v17 offset:128
    ds_read_b64_tr_b16 v[50:51], v17 offset:2688
    s_waitcnt vmcnt(2) lgkmcnt(10)
    buffer_load_dwordx4 v[184:187], v5, s[8:11], s56 offen offset:1024 sc1
    buffer_load_dwordx4 v[188:191], v5, s[8:11], s57 offen offset:1024 sc1
    v_mfma_f32_16x16x32_bf16 v[72:75], v[52:55], v[168:171], v[72:75]
    v_mfma_f32_16x16x32_bf16 v[92:95], v[52:55], v[172:175], v[92:95]
    v_mfma_f32_16x16x32_bf16 v[76:79], v[56:59], v[168:171], v[76:79]
    v_mfma_f32_16x16x32_bf16 v[96:99], v[56:59], v[172:175], v[96:99]
    v_mfma_f32_16x16x32_bf16 v[80:83], v[60:63], v[168:171], v[80:83]
    v_mfma_f32_16x16x32_bf16 v[100:103], v[60:63], v[172:175], v[100:103]
    v_mfma_f32_16x16x32_bf16 v[84:87], v[64:67], v[168:171], v[84:87]
    v_mfma_f32_16x16x32_bf16 v[104:107], v[64:67], v[172:175], v[104:107]
    v_mfma_f32_16x16x32_bf16 v[88:91], v[68:71], v[168:171], v[88:91]
    v_mfma_f32_16x16x32_bf16 v[108:111], v[68:71], v[172:175], v[108:111]
    ds_read_b64_tr_b16 v[52:53], v17 offset:20480
    ds_read_b64_tr_b16 v[54:55], v17 offset:23040
    ds_read_b64_tr_b16 v[56:57], v17 offset:20512
    ds_read_b64_tr_b16 v[58:59], v17 offset:23072
    ds_read_b64_tr_b16 v[60:61], v17 offset:20544
    ds_read_b64_tr_b16 v[62:63], v17 offset:23104
    ds_read_b64_tr_b16 v[64:65], v17 offset:20576
    ds_read_b64_tr_b16 v[66:67], v17 offset:23136
    ds_read_b64_tr_b16 v[68:69], v17 offset:20608
    ds_read_b64_tr_b16 v[70:71], v17 offset:23168
    s_waitcnt vmcnt(2) lgkmcnt(10)
    v_mfma_f32_16x16x32_bf16 v[72:75], v[32:35], v[176:179], v[72:75]
    v_mfma_f32_16x16x32_bf16 v[92:95], v[32:35], v[180:183], v[92:95]
    v_mfma_f32_16x16x32_bf16 v[76:79], v[36:39], v[176:179], v[76:79]
    v_mfma_f32_16x16x32_bf16 v[96:99], v[36:39], v[180:183], v[96:99]
    v_mfma_f32_16x16x32_bf16 v[80:83], v[40:43], v[176:179], v[80:83]
    v_mfma_f32_16x16x32_bf16 v[100:103], v[40:43], v[180:183], v[100:103]
    v_mfma_f32_16x16x32_bf16 v[84:87], v[44:47], v[176:179], v[84:87]
    v_mfma_f32_16x16x32_bf16 v[104:107], v[44:47], v[180:183], v[104:107]
    v_mfma_f32_16x16x32_bf16 v[88:91], v[48:51], v[176:179], v[88:91]
    v_mfma_f32_16x16x32_bf16 v[108:111], v[48:51], v[180:183], v[108:111]
    s_waitcnt vmcnt(0) lgkmcnt(0)
    v_mfma_f32_16x16x32_bf16 v[72:75], v[52:55], v[184:187], v[72:75]
    v_mfma_f32_16x16x32_bf16 v[92:95], v[52:55], v[188:191], v[92:95]
    v_mfma_f32_16x16x32_bf16 v[76:79], v[56:59], v[184:187], v[76:79]
    v_mfma_f32_16x16x32_bf16 v[96:99], v[56:59], v[188:191], v[96:99]
    v_mfma_f32_16x16x32_bf16 v[80:83], v[60:63], v[184:187], v[80:83]
    v_mfma_f32_16x16x32_bf16 v[100:103], v[60:63], v[188:191], v[100:103]
    v_mfma_f32_16x16x32_bf16 v[84:87], v[64:67], v[184:187], v[84:87]
    v_mfma_f32_16x16x32_bf16 v[104:107], v[64:67], v[188:191], v[104:107]
    v_mfma_f32_16x16x32_bf16 v[88:91], v[68:71], v[184:187], v[88:91]
    v_mfma_f32_16x16x32_bf16 v[108:111], v[68:71], v[188:191], v[108:111]
    s_barrier
    s_nop 5
    ds_write_b128 v18, v[72:75] offset:0
    ds_write_b128 v18, v[76:79] offset:64
    ds_write_b128 v18, v[80:83] offset:128
    ds_write_b128 v18, v[84:87] offset:192
    ds_write_b128 v18, v[88:91] offset:256
    ds_write_b128 v18, v[92:95] offset:5376
    ds_write_b128 v18, v[96:99] offset:5440
    ds_write_b128 v18, v[100:103] offset:5504
    ds_write_b128 v18, v[104:107] offset:5568
    ds_write_b128 v18, v[108:111] offset:5632
    s_waitcnt lgkmcnt(0)
    s_barrier
    ds_read_b128 v[112:115], v20 offset:0
    ds_read_b128 v[116:119], v20 offset:16
    ds_read_b128 v[120:123], v20 offset:21504
    ds_read_b128 v[124:127], v20 offset:21520
    ds_read_b128 v[128:131], v20 offset:43008
    ds_read_b128 v[132:135], v20 offset:43024
    ds_read_b128 v[136:139], v20 offset:64512
    ds_read_b128 v[140:143], v20 offset:64528
    s_waitcnt lgkmcnt(4)
    v_add_f32 v112, v112, v120
    v_add_f32 v113, v113, v121
    v_add_f32 v114, v114, v122
    v_add_f32 v115, v115, v123
    v_add_f32 v116, v116, v124
    v_add_f32 v117, v117, v125
    v_add_f32 v118, v118, v126
    v_add_f32 v119, v119, v127
    s_waitcnt lgkmcnt(2)
    v_add_f32 v112, v112, v128
    v_add_f32 v113, v113, v129
    v_add_f32 v114, v114, v130
    v_add_f32 v115, v115, v131
    v_add_f32 v116, v116, v132
    v_add_f32 v117, v117, v133
    v_add_f32 v118, v118, v134
    v_add_f32 v119, v119, v135
    s_waitcnt lgkmcnt(0)
    v_add_f32 v112, v112, v136
    v_add_f32 v113, v113, v137
    v_add_f32 v114, v114, v138
    v_add_f32 v115, v115, v139
    v_add_f32 v116, v116, v140
    v_add_f32 v117, v117, v141
    v_add_f32 v118, v118, v142
    v_add_f32 v119, v119, v143
    v_cvt_pk_bf16_f32 v144, v112, v113
    v_cvt_pk_bf16_f32 v145, v114, v115
    v_cvt_pk_bf16_f32 v146, v116, v117
    v_cvt_pk_bf16_f32 v147, v118, v119
    buffer_store_dwordx4 v[144:147], v22, s[48:51], s36 offen
    s_cmp_ge_u32 s12, 2
    s_cbranch_scc1 L_k2_fin
    ds_read_b128 v[112:115], v21 offset:0
    ds_read_b128 v[116:119], v21 offset:16
    ds_read_b128 v[120:123], v21 offset:21504
    ds_read_b128 v[124:127], v21 offset:21520
    ds_read_b128 v[128:131], v21 offset:43008
    ds_read_b128 v[132:135], v21 offset:43024
    ds_read_b128 v[136:139], v21 offset:64512
    ds_read_b128 v[140:143], v21 offset:64528
    s_waitcnt lgkmcnt(4)
    v_add_f32 v112, v112, v120
    v_add_f32 v113, v113, v121
    v_add_f32 v114, v114, v122
    v_add_f32 v115, v115, v123
    v_add_f32 v116, v116, v124
    v_add_f32 v117, v117, v125
    v_add_f32 v118, v118, v126
    v_add_f32 v119, v119, v127
    s_waitcnt lgkmcnt(2)
    v_add_f32 v112, v112, v128
    v_add_f32 v113, v113, v129
    v_add_f32 v114, v114, v130
    v_add_f32 v115, v115, v131
    v_add_f32 v116, v116, v132
    v_add_f32 v117, v117, v133
    v_add_f32 v118, v118, v134
    v_add_f32 v119, v119, v135
    s_waitcnt lgkmcnt(0)
    v_add_f32 v112, v112, v136
    v_add_f32 v113, v113, v137
    v_add_f32 v114, v114, v138
    v_add_f32 v115, v115, v139
    v_add_f32 v116, v116, v140
    v_add_f32 v117, v117, v141
    v_add_f32 v118, v118, v142
    v_add_f32 v119, v119, v143
    v_cvt_pk_bf16_f32 v148, v112, v113
    v_cvt_pk_bf16_f32 v149, v114, v115
    v_cvt_pk_bf16_f32 v150, v116, v117
    v_cvt_pk_bf16_f32 v151, v118, v119
    buffer_store_dwordx4 v[148:151], v23, s[48:51], s36 offen
L_k2_fin:
L_k2_done:
    s_endpgm
L_k2_slow:
    s_mov_b32 s30, 1
    v_lshrrev_b32 v13, 5, v1
    v_mul_u32_u24 v13, 320, v13
    v_lshl_add_u32 v4, v10, 4, v13
    v_mov_b32 v80, 0
    v_mov_b32 v112, 0
    v_mov_b32 v81, 0
    v_mov_b32 v113, 0
    v_mov_b32 v82, 0
    v_mov_b32 v114, 0
    v_mov_b32 v83, 0
    v_mov_b32 v115, 0
    v_mov_b32 v84, 0
    v_mov_b32 v116, 0
    v_mov_b32 v85, 0
    v_mov_b32 v117, 0
    v_mov_b32 v86, 0
    v_mov_b32 v118, 0
    v_mov_b32 v87, 0
    v_mov_b32 v119, 0
    v_mov_b32 v88, 0
    v_mov_b32 v120, 0
    v_mov_b32 v89, 0
    v_mov_b32 v121, 0
    v_mov_b32 v90, 0
    v_mov_b32 v122, 0
    v_mov_b32 v91, 0
    v_mov_b32 v123, 0
    v_mov_b32 v92, 0
    v_mov_b32 v124, 0
    v_mov_b32 v93, 0
    v_mov_b32 v125, 0
    v_mov_b32 v94, 0
    v_mov_b32 v126, 0
    v_mov_b32 v95, 0
    v_mov_b32 v127, 0
    v_mov_b32 v6, 0xff800000
    v_mov_b32 v96, 0
    v_mov_b32 v128, 0
    v_mov_b32 v97, 0
    v_mov_b32 v129, 0
    v_mov_b32 v98, 0
    v_mov_b32 v130, 0
    v_mov_b32 v99, 0
    v_mov_b32 v131, 0
    v_mov_b32 v100, 0
    v_mov_b32 v132, 0
    v_mov_b32 v101, 0
    v_mov_b32 v133, 0
    v_mov_b32 v102, 0
    v_mov_b32 v134, 0
    v_mov_b32 v103, 0
    v_mov_b32 v135, 0
    v_mov_b32 v104, 0
    v_mov_b32 v136, 0
    v_mov_b32 v105, 0
    v_mov_b32 v137, 0
    v_mov_b32 v106, 0
    v_mov_b32 v138, 0
    v_mov_b32 v107, 0
    v_mov_b32 v139, 0
    v_mov_b32 v108, 0
    v_mov_b32 v140, 0
    v_mov_b32 v109, 0
    v_mov_b32 v141, 0
    v_mov_b32 v110, 0
    v_mov_b32 v142, 0
    v_mov_b32 v111, 0
    v_mov_b32 v143, 0
    v_mov_b32 v7, 0xff800000
    s_mov_b32 s26, 0
    s_mov_b32 s20, s14
L_k2_maxloop:
    buffer_load_dwordx4 v[32:35], v5, s[8:11], s20 offen
    buffer_load_dwordx2 v[36:37], v11, s[8:11], s20 offen
    s_waitcnt vmcnt(0)
    v_mfma_f32_32x32x16_bf16 v[144:159], v[32:35], v[16:19], v[80:95]
    v_mfma_f32_32x32x8_bf16 v[144:159], v[36:37], v[20:21], v[144:159]
    v_mfma_f32_32x32x16_bf16 v[160:175], v[32:35], v[24:27], v[96:111]
    v_mfma_f32_32x32x8_bf16 v[160:175], v[36:37], v[28:29], v[160:175]
    s_nop 7
    s_nop 7
    v_max3_f32 v6, v144, v145, v6
    v_max3_f32 v6, v146, v147, v6
    v_max3_f32 v6, v148, v149, v6
    v_max3_f32 v6, v150, v151, v6
    v_max3_f32 v6, v152, v153, v6
    v_max3_f32 v6, v154, v155, v6
    v_max3_f32 v6, v156, v157, v6
    v_max3_f32 v6, v158, v159, v6
    v_max3_f32 v7, v160, v161, v7
    v_max3_f32 v7, v162, v163, v7
    v_max3_f32 v7, v164, v165, v7
    v_max3_f32 v7, v166, v167, v7
    v_max3_f32 v7, v168, v169, v7
    v_max3_f32 v7, v170, v171, v7
    v_max3_f32 v7, v172, v173, v7
    v_max3_f32 v7, v174, v175, v7
    s_add_u32 s20, s20, 2560
    s_add_u32 s26, s26, 1
    s_cmp_lt_u32 s26, 64
    s_cbranch_scc1 L_k2_maxloop
    v_mov_b32 v13, v6
    s_nop 1
    v_permlane32_swap_b32 v13, v6
    v_max_f32 v6, v6, v13
    v_sub_f32 v80, 0, v6
    v_sub_f32 v81, 0, v6
    v_sub_f32 v82, 0, v6
    v_sub_f32 v83, 0, v6
    v_sub_f32 v84, 0, v6
    v_sub_f32 v85, 0, v6
    v_sub_f32 v86, 0, v6
    v_sub_f32 v87, 0, v6
    v_sub_f32 v88, 0, v6
    v_sub_f32 v89, 0, v6
    v_sub_f32 v90, 0, v6
    v_sub_f32 v91, 0, v6
    v_sub_f32 v92, 0, v6
    v_sub_f32 v93, 0, v6
    v_sub_f32 v94, 0, v6
    v_sub_f32 v95, 0, v6
    v_mov_b32 v13, v7
    s_nop 1
    v_permlane32_swap_b32 v13, v7
    v_max_f32 v7, v7, v13
    v_sub_f32 v96, 0, v7
    v_sub_f32 v97, 0, v7
    v_sub_f32 v98, 0, v7
    v_sub_f32 v99, 0, v7
    v_sub_f32 v100, 0, v7
    v_sub_f32 v101, 0, v7
    v_sub_f32 v102, 0, v7
    v_sub_f32 v103, 0, v7
    v_sub_f32 v104, 0, v7
    v_sub_f32 v105, 0, v7
    v_sub_f32 v106, 0, v7
    v_sub_f32 v107, 0, v7
    v_sub_f32 v108, 0, v7
    v_sub_f32 v109, 0, v7
    v_sub_f32 v110, 0, v7
    v_sub_f32 v111, 0, v7
    s_mov_b32 s26, 0
    s_mov_b32 s20, s14
L_k2_slowloop:
    buffer_load_dwordx4 v[32:35], v5, s[8:11], s20 offen
    buffer_load_dwordx2 v[36:37], v11, s[8:11], s20 offen
    s_add_u32 s20, s20, 2560
    s_mov_b64 exec, s[22:23]
    buffer_load_dwordx4 v[40:43], v4, s[8:11], s20 offen offset:1280
    buffer_load_dwordx4 v[44:47], v4, s[8:11], s20 offen offset:1920
    s_mov_b64 exec, -1
    s_waitcnt vmcnt(0)
    v_mfma_f32_32x32x16_bf16 v[144:159], v[32:35], v[16:19], v[80:95]
    v_mfma_f32_32x32x8_bf16 v[144:159], v[36:37], v[20:21], v[144:159]
    v_mfma_f32_32x32x16_bf16 v[160:175], v[32:35], v[24:27], v[96:111]
    v_mfma_f32_32x32x8_bf16 v[160:175], v[36:37], v[28:29], v[160:175]
    s_nop 7
    s_nop 7
    v_exp_f32 v144, v144
    v_exp_f32 v145, v145
    v_exp_f32 v146, v146
    v_exp_f32 v147, v147
    v_cvt_pk_bf16_f32 v64, v144, v145
    v_cvt_pk_bf16_f32 v65, v146, v147
    v_exp_f32 v148, v148
    v_exp_f32 v149, v149
    v_exp_f32 v150, v150
    v_exp_f32 v151, v151
    v_cvt_pk_bf16_f32 v66, v148, v149
    v_cvt_pk_bf16_f32 v67, v150, v151
    v_exp_f32 v152, v152
    v_exp_f32 v153, v153
    v_exp_f32 v154, v154
    v_exp_f32 v155, v155
    v_cvt_pk_bf16_f32 v68, v152, v153
    v_cvt_pk_bf16_f32 v69, v154, v155
    v_exp_f32 v156, v156
    v_exp_f32 v157, v157
    v_exp_f32 v158, v158
    v_exp_f32 v159, v159
    v_cvt_pk_bf16_f32 v70, v156, v157
    v_cvt_pk_bf16_f32 v71, v158, v159
    v_exp_f32 v160, v160
    v_exp_f32 v161, v161
    v_exp_f32 v162, v162
    v_exp_f32 v163, v163
    v_cvt_pk_bf16_f32 v72, v160, v161
    v_cvt_pk_bf16_f32 v73, v162, v163
    v_exp_f32 v164, v164
    v_exp_f32 v165, v165
    v_exp_f32 v166, v166
    v_exp_f32 v167, v167
    v_cvt_pk_bf16_f32 v74, v164, v165
    v_cvt_pk_bf16_f32 v75, v166, v167
    v_exp_f32 v168, v168
    v_exp_f32 v169, v169
    v_exp_f32 v170, v170
    v_exp_f32 v171, v171
    v_cvt_pk_bf16_f32 v76, v168, v169
    v_cvt_pk_bf16_f32 v77, v170, v171
    v_exp_f32 v172, v172
    v_exp_f32 v173, v173
    v_exp_f32 v174, v174
    v_exp_f32 v175, v175
    v_cvt_pk_bf16_f32 v78, v172, v173
    v_cvt_pk_bf16_f32 v79, v174, v175
    s_nop 1
    v_mfma_f32_32x32x16_bf16 v[112:127], v[40:43], v[64:67], v[112:127]
    v_mfma_f32_32x32x16_bf16 v[112:127], v[44:47], v[68:71], v[112:127]
    v_mfma_f32_32x32x16_bf16 v[128:143], v[40:43], v[72:75], v[128:143]
    v_mfma_f32_32x32x16_bf16 v[128:143], v[44:47], v[76:79], v[128:143]
    s_add_u32 s26, s26, 1
    s_cmp_lt_u32 s26, 64
    s_cbranch_scc1 L_k2_slowloop
    s_nop 7
    s_nop 7
    s_branch L_k2_epi
.p2align 4
.type L_wtab,@object
L_wtab:
.long 0, 12864, 35968, 8992
.long 16, 12880, 35984, 9008
.long 32, 12896, 37120, 9024
.long 48, 12912, 37136, 9040
.long 64, 12928, 37152, 9056
.long 80, 12944, 37168, 9072
.long 96, 14080, 37184, 9088
.long 112, 14096, 37200, 9104
.long 128, 14112, 37216, 15360
.long 144, 14128, 37232, 15376
.long 1280, 14144, 37248, 15392
.long 1296, 14160, 37264, 15408
.long 1312, 14176, 38400, 15424
.long 1328, 14192, 38416, 15440
.long 1344, 14208, 38432, 15456
.long 1360, 14224, 38448, 15472
.long 1376, 25600, 38464, 15488
.long 1392, 25616, 38480, 15504
.long 1408, 25632, 38496, 16640
.long 1424, 25648, 38512, 16656
.long 2560, 25664, 38528, 16672
.long 2576, 25680, 38544, 16688
.long 2592, 25696, 39680, 16704
.long 2608, 25712, 39696, 16720
.long 2624, 25728, 39712, 16736
.long 2640, 25744, 39728, 16752
.long 2656, 26880, 39744, 16768
.long 2672, 26896, 39760, 16784
.long 2688, 26912, 39776, 17920
.long 2704, 26928, 39792, 17936
.long 3840, 26944, 39808, 17952
.long 3856, 26960, 39824, 17968
.long 3872, 26976, 5120, 17984
.long 3888, 26992, 5136, 18000
.long 3904, 27008, 5152, 18016
.long 3920, 27024, 5168, 18032
.long 3936, 28160, 5184, 18048
.long 3952, 28176, 5200, 18064
.long 3968, 28192, 5216, 19200
.long 3984, 28208, 5232, 19216
.long 10240, 28224, 5248, 19232
.long 10256, 28240, 5264, 19248
.long 10272, 28256, 6400, 19264
.long 10288, 28272, 6416, 19280
.long 10304, 28288, 6432, 19296
.long 10320, 28304, 6448, 19312
.long 10336, 29440, 6464, 19328
.long 10352, 29456, 6480, 19344
.long 10368, 29472, 6496, 30720
.long 10384, 29488, 6512, 30736
.long 11520, 29504, 6528, 30752
.long 11536, 29520, 6544, 30768
.long 11552, 29536, 7680, 30784
.long 11568, 29552, 7696, 30800
.long 11584, 29568, 7712, 30816
.long 11600, 29584, 7728, 30832
.long 11616, 35840, 7744, 30848
.long 11632, 35856, 7760, 30864
.long 11648, 35872, 7776, 32000
.long 11664, 35888, 7792, 32016
.long 12800, 35904, 7808, 32032
.long 12816, 35920, 7824, 32048
.long 12832, 35936, 8960, 32064
.long 12848, 35952, 8976, 32080
.long 32096, 20480, 74304, 174208
.long 32112, 20496, 74320, 174224
.long 32128, 20512, 74336, 175360
.long 32144, 20528, 74352, 175376
.long 33280, 20544, 74368, 175392
.long 33296, 20560, 74384, 175408
.long 33312, 20576, 75520, 175424
.long 33328, 20592, 75536, 175440
.long 33344, 20608, 75552, 175456
.long 33360, 20624, 75568, 175472
.long 33376, 21760, 75584, 175488
.long 33392, 21776, 75600, 175504
.long 33408, 21792, 75616, 176640
.long 33424, 21808, 75632, 176656
.long 34560, 21824, 75648, 176672
.long 34576, 21840, 75664, 176688
.long 34592, 21856, 122880, 176704
.long 34608, 21872, 122896, 176720
.long 34624, 21888, 122912, 176736
.long 34640, 21904, 122928, 176752
.long 34656, 23040, 122944, 176768
.long 34672, 23056, 122960, 176784
.long 34688, 23072, 122976, 177920
.long 34704, 23088, 122992, 177936
.long 40960, 23104, 123008, 177952
.long 40976, 23120, 123024, 177968
.long 40992, 23136, 124160, 177984
.long 41008, 23152, 124176, 178000
.long 41024, 23168, 124192, 178016
.long 41040, 23184, 124208, 178032
.long 41056, 24320, 124224, 178048
.long 41072, 24336, 124240, 178064
.long 41088, 24352, 124256, 46080
.long 41104, 24368, 124272, 46096
.long 42240, 24384, 124288, 46112
.long 42256, 24400, 124304, 46128
.long 42272, 24416, 125440, 46144
.long 42288, 24432, 125456, 46160
.long 42304, 24448, 125472, 46176
.long 42320, 24464, 125488, 46192
.long 42336, 71680, 125504, 46208
.long 42352, 71696, 125520, 46224
.long 42368, 71712, 125536, 47360
.long 42384, 71728, 125552, 47376
.long 43520, 71744, 125568, 47392
.long 43536, 71760, 125584, 47408
.long 43552, 71776, 126720, 47424
.long 43568, 71792, 126736, 47440
.long 43584, 71808, 126752, 47456
.long 43600, 71824, 126768, 47472
.long 43616, 72960, 126784, 47488
.long 43632, 72976, 126800, 47504
.long 43648, 72992, 126816, 48640
.long 43664, 73008, 126832, 48656
.long 44800, 73024, 126848, 48672
.long 44816, 73040, 126864, 48688
.long 44832, 73056, 174080, 48704
.long 44848, 73072, 174096, 48720
.long 44864, 73088, 174112, 48736
.long 44880, 73104, 174128, 48752
.long 44896, 74240, 174144, 48768
.long 44912, 74256, 174160, 48784
.long 44928, 74272, 174176, 49920
.long 44944, 74288, 174192, 49936
.long 49952, 149856, 0, 0
.long 49968, 149872, 0, 0
.long 49984, 149888, 0, 0
.long 50000, 149904, 0, 0
.long 50016, 151040, 0, 0
.long 50032, 151056, 0, 0
.long 50048, 151072, 0, 0
.long 50064, 151088, 0, 0
.long 97280, 151104, 0, 0
.long 97296, 151120, 0, 0
.long 97312, 151136, 0, 0
.long 97328, 151152, 0, 0
.long 97344, 151168, 0, 0
.long 97360, 151184, 0, 0
.long 97376, 152320, 0, 0
.long 97392, 152336, 0, 0
.long 97408, 152352, 0, 0
.long 97424, 152368, 0, 0
.long 98560, 152384, 0, 0
.long 98576, 152400, 0, 0
.long 98592, 152416, 0, 0
.long 98608, 152432, 0, 0
.long 98624, 152448, 0, 0
.long 98640, 152464, 0, 0
.long 98656, 199680, 0, 0
.long 98672, 199696, 0, 0
.long 98688, 199712, 0, 0
.long 98704, 199728, 0, 0
.long 99840, 199744, 0, 0
.long 99856, 199760, 0, 0
.long 99872, 199776, 0, 0
.long 99888, 199792, 0, 0
.long 99904, 199808, 0, 0
.long 99920, 199824, 0, 0
.long 99936, 200960, 0, 0
.long 99952, 200976, 0, 0
.long 99968, 200992, 0, 0
.long 99984, 201008, 0, 0
.long 101120, 201024, 0, 0
.long 101136, 201040, 0, 0
.long 101152, 201056, 0, 0
.long 101168, 201072, 0, 0
.long 101184, 201088, 0, 0
.long 101200, 201104, 0, 0
.long 101216, 202240, 0, 0
.long 101232, 202256, 0, 0
.long 101248, 202272, 0, 0
.long 101264, 202288, 0, 0
.long 148480, 202304, 0, 0
.long 148496, 202320, 0, 0
.long 148512, 202336, 0, 0
.long 148528, 202352, 0, 0
.long 148544, 202368, 0, 0
.long 148560, 202384, 0, 0
.long 148576, 203520, 0, 0
.long 148592, 203536, 0, 0
.long 148608, 203552, 0, 0
.long 148624, 203568, 0, 0
.long 149760, 203584, 0, 0
.long 149776, 203600, 0, 0
.long 149792, 203616, 0, 0
.long 149808, 203632, 0, 0
.long 149824, 203648, 0, 0
.long 149840, 203664, 0, 0
.size L_wtab, 3072
L_code_end:
.section .rodata,"a"
.p2align 6
.amdhsa_kernel gmix_proj_kernel
.amdhsa_next_free_vgpr 256
.amdhsa_next_free_sgpr 96
.amdhsa_accum_offset 256
.amdhsa_group_segment_fixed_size 0
.amdhsa_kernarg_size 96
.amdhsa_user_sgpr_count 2
.amdhsa_user_sgpr_kernarg_segment_ptr 1
.amdhsa_system_sgpr_workgroup_id_x 1
.end_amdhsa_kernel
.p2align 6
.amdhsa_kernel gmix_attn_kernel
.amdhsa_next_free_vgpr 240
.amdhsa_next_free_sgpr 64
.amdhsa_accum_offset 240
.amdhsa_group_segment_fixed_size 0
.amdhsa_kernarg_size 96
.amdhsa_user_sgpr_count 2
.amdhsa_user_sgpr_kernarg_segment_ptr 1
.amdhsa_system_sgpr_workgroup_id_x 1
.end_amdhsa_kernel
```
